```python
import torch

def _softmax(x, axis=-1):
    return torch.softmax(x, dim=axis)

def _gelu(x):
    return torch.nn.functional.gelu(x, approximate='tanh')

def _silu(x):
    return torch.nn.functional.silu(x)

def _sigmoid(x):
    return torch.sigmoid(x)

def _layernorm(x, axis=-1, eps=1e-05):
    m = x.mean(dim=axis, keepdim=True)
    v = x.var(dim=axis, keepdim=True, unbiased=False)
    return (x - m) / torch.sqrt(v + eps)

def _scatter_add(tgt, idx, src, axis=0):
    return tgt.clone().index_add_(axis, idx, src)

def _segment_sum(src, seg, n):
    out = torch.zeros((n,) + src.shape[1:], dtype=src.dtype)
    return out.index_add_(0, seg, src)

def _pad(x, pw):
    flat = tuple((v for pair in reversed(pw) for v in pair))
    return torch.nn.functional.pad(x, flat)
kernel_name = 'interleave_layers__ssm_conv_h3__mixer_gmlp__prompt'

def setup_inputs():

    _w = lambda a: (lambda t: t.to(torch.bfloat16) if t.is_floating_point() else t)(torch.as_tensor(a))

    def _A_setup():
        B, S, D = (1, 2048, 640)
        ks = 4
        return {'q': _w((lambda *s: torch.randn(*s, dtype=torch.bfloat16) * 0.05)(B, S, D)), 'k': _w((lambda *s: torch.randn(*s, dtype=torch.bfloat16) * 0.8)(B, S, D)), 'v': _w((lambda *s: torch.randn(*s, dtype=torch.bfloat16) * 0.8)(B, S, D)), 'shift_k': _w((lambda *s: torch.randn(*s, dtype=torch.bfloat16) * 0.8)(D, ks) * 0.5), 'ssm_k': _w((lambda *s: torch.randn(*s, dtype=torch.bfloat16) * 0.8)(D, S) * (1.0 / S ** 0.5)), 'ssm_D': _w((lambda *s: torch.randn(*s, dtype=torch.bfloat16) * 0.8)(D))}
    _A_in = _A_setup()

    def _B_setup():
        B, S, D, F = (1, 2048, 640, 1536)
        Fh = F // 2
        return {'x': _w((lambda *s: torch.randn(*s, dtype=torch.bfloat16) * 0.05)(B, S, D)), 'w_in': _w((lambda *s: torch.randn(*s, dtype=torch.bfloat16) * 0.4)(D, 2 * Fh)), 'w_sp': _w(0.01 * (lambda *s: torch.randn(*s, dtype=torch.bfloat16) * 0.4)(S, S)), 'b_sp': _w(1.0 + 0.01 * (lambda *s: torch.randn(*s, dtype=torch.bfloat16) * 0.1)(S)), 'w_out': _w((lambda *s: torch.randn(*s, dtype=torch.bfloat16) * 0.1)(Fh, D))}
    _B_in = _B_setup()
    return {'A_q': _A_in['q'], 'A_k': _A_in['k'], 'A_v': _A_in['v'], 'A_shift_k': _A_in['shift_k'], 'A_ssm_k': _A_in['ssm_k'], 'A_ssm_D': _A_in['ssm_D'], 'B_x': _B_in['x'], 'B_w_in': _B_in['w_in'], 'B_w_sp': _B_in['w_sp'], 'B_b_sp': _B_in['b_sp'], 'B_w_out': _B_in['w_out']}

def reference(A_q, A_k, A_v, A_shift_k, A_ssm_k, A_ssm_D, B_x, B_w_in, B_w_sp, B_b_sp, B_w_out):

    def _A_ref(q, k, v, shift_k, ssm_k, ssm_D):
        B, S, D = q.shape
        ks = shift_k.shape[-1]
        k_pad = _pad(k, ((0, 0), (ks - 1, 0), (0, 0)))
        k_shift = torch.zeros_like(k)
        for t in range(ks):
            k_shift = k_shift + k_pad[:, t:t + S, :] * shift_k[:, ks - 1 - t][None, None, :]
        kv = k_shift * v
        L = 2 * S
        kv_pad = _pad(kv, ((0, 0), (0, S), (0, 0)))
        kf_pad = _pad(ssm_k, ((0, 0), (0, S)))
        kv_f = (lambda x, axes=(-2, -1): torch.fft.rfft2(x.float(), dim=axes))(kv_pad[:, None, :, :], axes=(1, 2))
        kf_f = (lambda x, axes=(-2, -1): torch.fft.rfft2(x.float(), dim=axes))(kf_pad[:, None, :], axes=(1, 2))
        kf_f = (lambda x, *d: x.permute(*d))(kf_f, 1, 2, 0)
        y_f = kv_f * kf_f[None, :, :, :]
        y = (lambda x, s, axes=(-2, -1): torch.fft.irfft2(x, s=s, dim=axes).to(torch.bfloat16))(y_f, (1, L), axes=(1, 2))[:, 0, :S, :]
        y = y + kv * ssm_D[None, None, :]
        return q * y

    def _B_ref(x, w_in, w_sp, b_sp, w_out):
        B, S, D = x.shape
        F = w_in.shape[-1]
        Fh = F // 2
        z = _gelu(torch.einsum('bsd,df->bsf', x, w_in))
        z1 = z[..., :Fh].clone()
        z2 = _layernorm(z[..., Fh:], axis=-1)
        g = torch.einsum('ts,bsf->btf', w_sp, z2) + b_sp[None, :, None]
        return torch.einsum('bsf,fd->bsd', z1 * g, w_out)
    x = A_q
    x = x + _A_ref(_layernorm(x, axis=-1), A_k, A_v, A_shift_k, A_ssm_k, A_ssm_D)
    x = x + _B_ref(_layernorm(x, axis=-1), B_w_in, B_w_sp, B_b_sp, B_w_out)
    x = x + _A_ref(_layernorm(x, axis=-1), A_k, A_v, A_shift_k, A_ssm_k, A_ssm_D)
    x = x + _B_ref(_layernorm(x, axis=-1), B_w_in, B_w_sp, B_b_sp, B_w_out)
    return x
```

```asm
; @launch kernel=prep_kernel grid=(200,1,1) block=(512,1,1) lds=0
; @launch kernel=conv_kernel grid=(760,1,1) block=(256,1,1) lds=40880
; @launch kernel=lnx0_kernel grid=(256,1,1) block=(512,1,1) lds=10560
; @launch kernel=gemm1_0_kernel grid=(256,1,1) block=(512,1,1) lds=143360
; @launch kernel=lnz0_kernel grid=(256,1,1) block=(512,1,1) lds=12672
; @launch kernel=gemm2_0_kernel grid=(256,1,1) block=(512,1,1) lds=143360
; @launch kernel=gemm3_0_kernel grid=(256,1,1) block=(512,1,1) lds=143360
; @launch kernel=lnx1_kernel grid=(256,1,1) block=(512,1,1) lds=0
; @launch kernel=gemm1_0_kernel grid=(256,1,1) block=(512,1,1) lds=143360
; @launch kernel=lnz0_kernel grid=(256,1,1) block=(512,1,1) lds=12672
; @launch kernel=gemm2_0_kernel grid=(256,1,1) block=(512,1,1) lds=143360
; @launch kernel=gemm3_1_kernel grid=(256,1,1) block=(512,1,1) lds=143360
.amdgcn_target "amdgcn-amd-amdhsa--gfx950"
.text
.globl prep_kernel
.p2align 8
.type prep_kernel,@function
prep_kernel:
    s_cmp_ge_u32 s2, 200
    s_cbranch_scc1 L_prep_end
    s_cmp_ge_u32 s2, 160
    s_cbranch_scc1 L_prep_touch
    s_load_dwordx2 s[4:5], s[0:1], 104
    s_mov_b32 s30, 0x05040100
    s_mov_b32 s31, 0x07060302
    s_load_dwordx4 s[24:27], s[0:1], 8
    s_load_dwordx2 s[28:29], s[0:1], 24
    s_mul_i32 s3, s2, 52429
    s_lshr_b32 s3, s3, 18
    s_mul_i32 s6, s3, 5
    s_sub_u32 s6, s2, s6
    s_lshl_b32 s6, s6, 6
    s_lshl_b32 s3, s3, 3
    v_and_b32 v1, 63, v0
    v_add_u32 v1, s6, v1
    v_lshrrev_b32 v2, 6, v0
    v_add_u32 v2, s3, v2
    v_mul_u32_u24 v3, 10240, v2
    v_lshl_add_u32 v3, v1, 2, v3
    v_lshlrev_b32 v4, 4, v1
    s_waitcnt lgkmcnt(0)
    s_mov_b32 s8, s24
    s_mov_b32 s9, s25
    s_mov_b32 s10, 2621440
    s_mov_b32 s11, 0x00020000
    s_mov_b32 s12, s26
    s_mov_b32 s13, s27
    s_mov_b32 s14, 2621440
    s_mov_b32 s15, 0x00020000
    s_mov_b32 s16, s28
    s_mov_b32 s17, s29
    s_mov_b32 s18, 5120
    s_mov_b32 s19, 0x00020000
    s_mov_b32 s20, s4
    s_mov_b32 s21, s5
    s_mov_b32 s22, 2703360
    s_mov_b32 s23, 0x00020000
    buffer_load_dwordx4 v[48:51], v4, s[16:19], 0 offen
    v_add_u32 v4, 4294963456, v3
    buffer_load_dword v10, v4, s[8:11], 0 offen
    v_add_u32 v4, 4294964736, v3
    buffer_load_dword v11, v4, s[8:11], 0 offen
    v_add_u32 v4, 4294966016, v3
    buffer_load_dword v12, v4, s[8:11], 0 offen
    v_add_u32 v4, 5120, v3
    buffer_load_dword v13, v3, s[8:11], 0 offen offset:0
    buffer_load_dword v14, v3, s[8:11], 0 offen offset:1280
    buffer_load_dword v15, v3, s[8:11], 0 offen offset:2560
    buffer_load_dword v16, v3, s[8:11], 0 offen offset:3840
    buffer_load_dword v17, v4, s[8:11], 0 offen offset:0
    buffer_load_dword v18, v4, s[8:11], 0 offen offset:1280
    buffer_load_dword v19, v4, s[8:11], 0 offen offset:2560
    buffer_load_dword v20, v4, s[8:11], 0 offen offset:3840
    buffer_load_dword v30, v3, s[12:15], 0 offen offset:0
    buffer_load_dword v31, v3, s[12:15], 0 offen offset:1280
    buffer_load_dword v32, v3, s[12:15], 0 offen offset:2560
    buffer_load_dword v33, v3, s[12:15], 0 offen offset:3840
    buffer_load_dword v34, v4, s[12:15], 0 offen offset:0
    buffer_load_dword v35, v4, s[12:15], 0 offen offset:1280
    buffer_load_dword v36, v4, s[12:15], 0 offen offset:2560
    buffer_load_dword v37, v4, s[12:15], 0 offen offset:3840
    s_waitcnt vmcnt(8)
    v_lshlrev_b32 v92, 16, v48
    v_and_b32 v94, 0xffff0000, v48
    v_lshlrev_b32 v96, 16, v49
    v_and_b32 v98, 0xffff0000, v49
    v_lshlrev_b32 v93, 16, v50
    v_and_b32 v95, 0xffff0000, v50
    v_lshlrev_b32 v97, 16, v51
    v_and_b32 v99, 0xffff0000, v51
    v_lshlrev_b32 v52, 16, v10
    v_and_b32 v53, 0xffff0000, v10
    v_lshlrev_b32 v54, 16, v11
    v_and_b32 v55, 0xffff0000, v11
    v_lshlrev_b32 v56, 16, v12
    v_and_b32 v57, 0xffff0000, v12
    v_lshlrev_b32 v58, 16, v13
    v_and_b32 v59, 0xffff0000, v13
    v_lshlrev_b32 v60, 16, v14
    v_and_b32 v61, 0xffff0000, v14
    v_lshlrev_b32 v62, 16, v15
    v_and_b32 v63, 0xffff0000, v15
    v_lshlrev_b32 v64, 16, v16
    v_and_b32 v65, 0xffff0000, v16
    v_lshlrev_b32 v66, 16, v17
    v_and_b32 v67, 0xffff0000, v17
    v_lshlrev_b32 v68, 16, v18
    v_and_b32 v69, 0xffff0000, v18
    v_lshlrev_b32 v70, 16, v19
    v_and_b32 v71, 0xffff0000, v19
    v_lshlrev_b32 v72, 16, v20
    v_and_b32 v73, 0xffff0000, v20
    s_waitcnt vmcnt(0)
    v_pk_mul_f32 v[100:101], v[52:53], v[98:99]
    v_cvt_pk_bf16_f32 v104, v100, v101
    v_lshlrev_b32 v100, 16, v104
    v_and_b32 v101, 0xffff0000, v104
    v_pk_mul_f32 v[102:103], v[54:55], v[96:97]
    v_cvt_pk_bf16_f32 v104, v102, v103
    v_lshlrev_b32 v102, 16, v104
    v_and_b32 v103, 0xffff0000, v104
    v_pk_add_f32 v[100:101], v[100:101], v[102:103]
    v_cvt_pk_bf16_f32 v104, v100, v101
    v_lshlrev_b32 v100, 16, v104
    v_and_b32 v101, 0xffff0000, v104
    v_pk_mul_f32 v[102:103], v[56:57], v[94:95]
    v_cvt_pk_bf16_f32 v104, v102, v103
    v_lshlrev_b32 v102, 16, v104
    v_and_b32 v103, 0xffff0000, v104
    v_pk_add_f32 v[100:101], v[100:101], v[102:103]
    v_cvt_pk_bf16_f32 v104, v100, v101
    v_lshlrev_b32 v100, 16, v104
    v_and_b32 v101, 0xffff0000, v104
    v_pk_mul_f32 v[102:103], v[58:59], v[92:93]
    v_cvt_pk_bf16_f32 v104, v102, v103
    v_lshlrev_b32 v102, 16, v104
    v_and_b32 v103, 0xffff0000, v104
    v_pk_add_f32 v[100:101], v[100:101], v[102:103]
    v_cvt_pk_bf16_f32 v104, v100, v101
    v_lshlrev_b32 v100, 16, v104
    v_and_b32 v101, 0xffff0000, v104
    v_lshlrev_b32 v102, 16, v30
    v_and_b32 v103, 0xffff0000, v30
    v_pk_mul_f32 v[100:101], v[100:101], v[102:103]
    v_cvt_pk_bf16_f32 v110, v100, v101
    v_pk_mul_f32 v[100:101], v[54:55], v[98:99]
    v_cvt_pk_bf16_f32 v104, v100, v101
    v_lshlrev_b32 v100, 16, v104
    v_and_b32 v101, 0xffff0000, v104
    v_pk_mul_f32 v[102:103], v[56:57], v[96:97]
    v_cvt_pk_bf16_f32 v104, v102, v103
    v_lshlrev_b32 v102, 16, v104
    v_and_b32 v103, 0xffff0000, v104
    v_pk_add_f32 v[100:101], v[100:101], v[102:103]
    v_cvt_pk_bf16_f32 v104, v100, v101
    v_lshlrev_b32 v100, 16, v104
    v_and_b32 v101, 0xffff0000, v104
    v_pk_mul_f32 v[102:103], v[58:59], v[94:95]
    v_cvt_pk_bf16_f32 v104, v102, v103
    v_lshlrev_b32 v102, 16, v104
    v_and_b32 v103, 0xffff0000, v104
    v_pk_add_f32 v[100:101], v[100:101], v[102:103]
    v_cvt_pk_bf16_f32 v104, v100, v101
    v_lshlrev_b32 v100, 16, v104
    v_and_b32 v101, 0xffff0000, v104
    v_pk_mul_f32 v[102:103], v[60:61], v[92:93]
    v_cvt_pk_bf16_f32 v104, v102, v103
    v_lshlrev_b32 v102, 16, v104
    v_and_b32 v103, 0xffff0000, v104
    v_pk_add_f32 v[100:101], v[100:101], v[102:103]
    v_cvt_pk_bf16_f32 v104, v100, v101
    v_lshlrev_b32 v100, 16, v104
    v_and_b32 v101, 0xffff0000, v104
    v_lshlrev_b32 v102, 16, v31
    v_and_b32 v103, 0xffff0000, v31
    v_pk_mul_f32 v[100:101], v[100:101], v[102:103]
    v_cvt_pk_bf16_f32 v111, v100, v101
    v_pk_mul_f32 v[100:101], v[56:57], v[98:99]
    v_cvt_pk_bf16_f32 v104, v100, v101
    v_lshlrev_b32 v100, 16, v104
    v_and_b32 v101, 0xffff0000, v104
    v_pk_mul_f32 v[102:103], v[58:59], v[96:97]
    v_cvt_pk_bf16_f32 v104, v102, v103
    v_lshlrev_b32 v102, 16, v104
    v_and_b32 v103, 0xffff0000, v104
    v_pk_add_f32 v[100:101], v[100:101], v[102:103]
    v_cvt_pk_bf16_f32 v104, v100, v101
    v_lshlrev_b32 v100, 16, v104
    v_and_b32 v101, 0xffff0000, v104
    v_pk_mul_f32 v[102:103], v[60:61], v[94:95]
    v_cvt_pk_bf16_f32 v104, v102, v103
    v_lshlrev_b32 v102, 16, v104
    v_and_b32 v103, 0xffff0000, v104
    v_pk_add_f32 v[100:101], v[100:101], v[102:103]
    v_cvt_pk_bf16_f32 v104, v100, v101
    v_lshlrev_b32 v100, 16, v104
    v_and_b32 v101, 0xffff0000, v104
    v_pk_mul_f32 v[102:103], v[62:63], v[92:93]
    v_cvt_pk_bf16_f32 v104, v102, v103
    v_lshlrev_b32 v102, 16, v104
    v_and_b32 v103, 0xffff0000, v104
    v_pk_add_f32 v[100:101], v[100:101], v[102:103]
    v_cvt_pk_bf16_f32 v104, v100, v101
    v_lshlrev_b32 v100, 16, v104
    v_and_b32 v101, 0xffff0000, v104
    v_lshlrev_b32 v102, 16, v32
    v_and_b32 v103, 0xffff0000, v32
    v_pk_mul_f32 v[100:101], v[100:101], v[102:103]
    v_cvt_pk_bf16_f32 v112, v100, v101
    v_pk_mul_f32 v[100:101], v[58:59], v[98:99]
    v_cvt_pk_bf16_f32 v104, v100, v101
    v_lshlrev_b32 v100, 16, v104
    v_and_b32 v101, 0xffff0000, v104
    v_pk_mul_f32 v[102:103], v[60:61], v[96:97]
    v_cvt_pk_bf16_f32 v104, v102, v103
    v_lshlrev_b32 v102, 16, v104
    v_and_b32 v103, 0xffff0000, v104
    v_pk_add_f32 v[100:101], v[100:101], v[102:103]
    v_cvt_pk_bf16_f32 v104, v100, v101
    v_lshlrev_b32 v100, 16, v104
    v_and_b32 v101, 0xffff0000, v104
    v_pk_mul_f32 v[102:103], v[62:63], v[94:95]
    v_cvt_pk_bf16_f32 v104, v102, v103
    v_lshlrev_b32 v102, 16, v104
    v_and_b32 v103, 0xffff0000, v104
    v_pk_add_f32 v[100:101], v[100:101], v[102:103]
    v_cvt_pk_bf16_f32 v104, v100, v101
    v_lshlrev_b32 v100, 16, v104
    v_and_b32 v101, 0xffff0000, v104
    v_pk_mul_f32 v[102:103], v[64:65], v[92:93]
    v_cvt_pk_bf16_f32 v104, v102, v103
    v_lshlrev_b32 v102, 16, v104
    v_and_b32 v103, 0xffff0000, v104
    v_pk_add_f32 v[100:101], v[100:101], v[102:103]
    v_cvt_pk_bf16_f32 v104, v100, v101
    v_lshlrev_b32 v100, 16, v104
    v_and_b32 v101, 0xffff0000, v104
    v_lshlrev_b32 v102, 16, v33
    v_and_b32 v103, 0xffff0000, v33
    v_pk_mul_f32 v[100:101], v[100:101], v[102:103]
    v_cvt_pk_bf16_f32 v113, v100, v101
    v_pk_mul_f32 v[100:101], v[60:61], v[98:99]
    v_cvt_pk_bf16_f32 v104, v100, v101
    v_lshlrev_b32 v100, 16, v104
    v_and_b32 v101, 0xffff0000, v104
    v_pk_mul_f32 v[102:103], v[62:63], v[96:97]
    v_cvt_pk_bf16_f32 v104, v102, v103
    v_lshlrev_b32 v102, 16, v104
    v_and_b32 v103, 0xffff0000, v104
    v_pk_add_f32 v[100:101], v[100:101], v[102:103]
    v_cvt_pk_bf16_f32 v104, v100, v101
    v_lshlrev_b32 v100, 16, v104
    v_and_b32 v101, 0xffff0000, v104
    v_pk_mul_f32 v[102:103], v[64:65], v[94:95]
    v_cvt_pk_bf16_f32 v104, v102, v103
    v_lshlrev_b32 v102, 16, v104
    v_and_b32 v103, 0xffff0000, v104
    v_pk_add_f32 v[100:101], v[100:101], v[102:103]
    v_cvt_pk_bf16_f32 v104, v100, v101
    v_lshlrev_b32 v100, 16, v104
    v_and_b32 v101, 0xffff0000, v104
    v_pk_mul_f32 v[102:103], v[66:67], v[92:93]
    v_cvt_pk_bf16_f32 v104, v102, v103
    v_lshlrev_b32 v102, 16, v104
    v_and_b32 v103, 0xffff0000, v104
    v_pk_add_f32 v[100:101], v[100:101], v[102:103]
    v_cvt_pk_bf16_f32 v104, v100, v101
    v_lshlrev_b32 v100, 16, v104
    v_and_b32 v101, 0xffff0000, v104
    v_lshlrev_b32 v102, 16, v34
    v_and_b32 v103, 0xffff0000, v34
    v_pk_mul_f32 v[100:101], v[100:101], v[102:103]
    v_cvt_pk_bf16_f32 v114, v100, v101
    v_pk_mul_f32 v[100:101], v[62:63], v[98:99]
    v_cvt_pk_bf16_f32 v104, v100, v101
    v_lshlrev_b32 v100, 16, v104
    v_and_b32 v101, 0xffff0000, v104
    v_pk_mul_f32 v[102:103], v[64:65], v[96:97]
    v_cvt_pk_bf16_f32 v104, v102, v103
    v_lshlrev_b32 v102, 16, v104
    v_and_b32 v103, 0xffff0000, v104
    v_pk_add_f32 v[100:101], v[100:101], v[102:103]
    v_cvt_pk_bf16_f32 v104, v100, v101
    v_lshlrev_b32 v100, 16, v104
    v_and_b32 v101, 0xffff0000, v104
    v_pk_mul_f32 v[102:103], v[66:67], v[94:95]
    v_cvt_pk_bf16_f32 v104, v102, v103
    v_lshlrev_b32 v102, 16, v104
    v_and_b32 v103, 0xffff0000, v104
    v_pk_add_f32 v[100:101], v[100:101], v[102:103]
    v_cvt_pk_bf16_f32 v104, v100, v101
    v_lshlrev_b32 v100, 16, v104
    v_and_b32 v101, 0xffff0000, v104
    v_pk_mul_f32 v[102:103], v[68:69], v[92:93]
    v_cvt_pk_bf16_f32 v104, v102, v103
    v_lshlrev_b32 v102, 16, v104
    v_and_b32 v103, 0xffff0000, v104
    v_pk_add_f32 v[100:101], v[100:101], v[102:103]
    v_cvt_pk_bf16_f32 v104, v100, v101
    v_lshlrev_b32 v100, 16, v104
    v_and_b32 v101, 0xffff0000, v104
    v_lshlrev_b32 v102, 16, v35
    v_and_b32 v103, 0xffff0000, v35
    v_pk_mul_f32 v[100:101], v[100:101], v[102:103]
    v_cvt_pk_bf16_f32 v115, v100, v101
    v_pk_mul_f32 v[100:101], v[64:65], v[98:99]
    v_cvt_pk_bf16_f32 v104, v100, v101
    v_lshlrev_b32 v100, 16, v104
    v_and_b32 v101, 0xffff0000, v104
    v_pk_mul_f32 v[102:103], v[66:67], v[96:97]
    v_cvt_pk_bf16_f32 v104, v102, v103
    v_lshlrev_b32 v102, 16, v104
    v_and_b32 v103, 0xffff0000, v104
    v_pk_add_f32 v[100:101], v[100:101], v[102:103]
    v_cvt_pk_bf16_f32 v104, v100, v101
    v_lshlrev_b32 v100, 16, v104
    v_and_b32 v101, 0xffff0000, v104
    v_pk_mul_f32 v[102:103], v[68:69], v[94:95]
    v_cvt_pk_bf16_f32 v104, v102, v103
    v_lshlrev_b32 v102, 16, v104
    v_and_b32 v103, 0xffff0000, v104
    v_pk_add_f32 v[100:101], v[100:101], v[102:103]
    v_cvt_pk_bf16_f32 v104, v100, v101
    v_lshlrev_b32 v100, 16, v104
    v_and_b32 v101, 0xffff0000, v104
    v_pk_mul_f32 v[102:103], v[70:71], v[92:93]
    v_cvt_pk_bf16_f32 v104, v102, v103
    v_lshlrev_b32 v102, 16, v104
    v_and_b32 v103, 0xffff0000, v104
    v_pk_add_f32 v[100:101], v[100:101], v[102:103]
    v_cvt_pk_bf16_f32 v104, v100, v101
    v_lshlrev_b32 v100, 16, v104
    v_and_b32 v101, 0xffff0000, v104
    v_lshlrev_b32 v102, 16, v36
    v_and_b32 v103, 0xffff0000, v36
    v_pk_mul_f32 v[100:101], v[100:101], v[102:103]
    v_cvt_pk_bf16_f32 v116, v100, v101
    v_pk_mul_f32 v[100:101], v[66:67], v[98:99]
    v_cvt_pk_bf16_f32 v104, v100, v101
    v_lshlrev_b32 v100, 16, v104
    v_and_b32 v101, 0xffff0000, v104
    v_pk_mul_f32 v[102:103], v[68:69], v[96:97]
    v_cvt_pk_bf16_f32 v104, v102, v103
    v_lshlrev_b32 v102, 16, v104
    v_and_b32 v103, 0xffff0000, v104
    v_pk_add_f32 v[100:101], v[100:101], v[102:103]
    v_cvt_pk_bf16_f32 v104, v100, v101
    v_lshlrev_b32 v100, 16, v104
    v_and_b32 v101, 0xffff0000, v104
    v_pk_mul_f32 v[102:103], v[70:71], v[94:95]
    v_cvt_pk_bf16_f32 v104, v102, v103
    v_lshlrev_b32 v102, 16, v104
    v_and_b32 v103, 0xffff0000, v104
    v_pk_add_f32 v[100:101], v[100:101], v[102:103]
    v_cvt_pk_bf16_f32 v104, v100, v101
    v_lshlrev_b32 v100, 16, v104
    v_and_b32 v101, 0xffff0000, v104
    v_pk_mul_f32 v[102:103], v[72:73], v[92:93]
    v_cvt_pk_bf16_f32 v104, v102, v103
    v_lshlrev_b32 v102, 16, v104
    v_and_b32 v103, 0xffff0000, v104
    v_pk_add_f32 v[100:101], v[100:101], v[102:103]
    v_cvt_pk_bf16_f32 v104, v100, v101
    v_lshlrev_b32 v100, 16, v104
    v_and_b32 v101, 0xffff0000, v104
    v_lshlrev_b32 v102, 16, v37
    v_and_b32 v103, 0xffff0000, v37
    v_pk_mul_f32 v[100:101], v[100:101], v[102:103]
    v_cvt_pk_bf16_f32 v117, v100, v101
    v_perm_b32 v120, v116, v117, s30
    v_perm_b32 v124, v116, v117, s31
    v_perm_b32 v121, v114, v115, s30
    v_perm_b32 v125, v114, v115, s31
    v_perm_b32 v122, v112, v113, s30
    v_perm_b32 v126, v112, v113, s31
    v_perm_b32 v123, v110, v111, s30
    v_perm_b32 v127, v110, v111, s31
    v_mul_u32_u24 v4, 8448, v1
    v_lshlrev_b32 v5, 4, v2
    v_sub_u32 v4, v4, v5
    v_add_u32 v4, 4080, v4
    v_add_u32 v5, 4224, v4
    buffer_store_dwordx4 v[120:123], v4, s[20:23], 0 offen
    buffer_store_dwordx4 v[124:127], v5, s[20:23], 0 offen
    s_branch L_prep_end
L_prep_touch:
    s_cmp_ge_u32 s2, 176
    s_cbranch_scc1 L_prep_t1
    s_getpc_b64 s[12:13]
L_prep_pc:
    s_add_u32 s12, s12, conv_kernel-L_prep_pc
    s_addc_u32 s13, s13, 0
    v_lshlrev_b32 v1, 4, v0
    s_mov_b32 s14, 0
L_prep_cl:
    v_cmp_gt_u32 vcc, L_text_end-conv_kernel-16, v1
    s_and_saveexec_b64 s[16:17], vcc
    s_cbranch_execz L_prep_cd
    global_load_dwordx4 v[48:51], v1, s[12:13]
    v_add_u32 v1, 8192, v1
    s_branch L_prep_cl
L_prep_cd:
    s_mov_b64 exec, -1
L_prep_t1:
    s_sub_u32 s3, s2, 160
    s_load_dwordx2 s[8:9], s[0:1], 32
    s_lshl_b32 s3, s3, 16
    v_lshlrev_b32 v1, 4, v0
    s_mov_b32 s10, 2621440
    s_mov_b32 s11, 0x00020000
    s_waitcnt lgkmcnt(0)
    buffer_load_dwordx4 v[8:11], v1, s[8:11], s3 offen
    s_add_u32 s3, s3, 8192
    buffer_load_dwordx4 v[12:15], v1, s[8:11], s3 offen
    s_add_u32 s3, s3, 8192
    buffer_load_dwordx4 v[16:19], v1, s[8:11], s3 offen
    s_add_u32 s3, s3, 8192
    buffer_load_dwordx4 v[20:23], v1, s[8:11], s3 offen
    s_add_u32 s3, s3, 8192
    buffer_load_dwordx4 v[24:27], v1, s[8:11], s3 offen
    s_add_u32 s3, s3, 8192
    buffer_load_dwordx4 v[28:31], v1, s[8:11], s3 offen
    s_add_u32 s3, s3, 8192
    buffer_load_dwordx4 v[32:35], v1, s[8:11], s3 offen
    s_add_u32 s3, s3, 8192
    buffer_load_dwordx4 v[36:39], v1, s[8:11], s3 offen
    s_add_u32 s3, s3, 8192
L_prep_end:
    s_endpgm
.globl conv_kernel
.p2align 8
.type conv_kernel,@function
conv_kernel:
    s_cmp_ge_u32 s2, 760
    s_cbranch_scc1 L_conv_end
    s_cmp_ge_u32 s2, 640
    s_cbranch_scc1 L_cw_w
    s_cmp_ge_u32 s2, 8
    s_cbranch_scc1 L_cpf_1
    v_lshlrev_b32 v1, 4, v0
    s_getpc_b64 s[100:101]
L_cpfpc_1_0:
    s_add_u32 s100, s100, lnx0_kernel-L_cpfpc_1_0
    s_addc_u32 s101, s101, (lnx0_kernel-L_cpfpc_1_0)>>32
    v_cmp_gt_u32 vcc, L_text_end-lnx0_kernel-16, v1
    s_and_saveexec_b64 s[98:99], vcc
    global_load_dwordx4 v[108:111], v1, s[100:101]
    s_mov_b64 exec, s[98:99]
L_cpf_1:
    s_load_dwordx4 s[24:27], s[0:1], 32
    s_load_dwordx2 s[4:5], s[0:1], 104
    s_load_dwordx2 s[36:37], s[0:1], 64
    s_lshl_b32 s3, s2, 12
    s_waitcnt lgkmcnt(0)
    s_add_u32 s24, s24, s3
    s_addc_u32 s25, s25, 0
    s_mov_b32 s8, s24
    s_mov_b32 s9, s25
    s_mov_b32 s10, 4096
    s_mov_b32 s11, 0x00020000
    s_mul_i32 s3, s2, 4224
    s_add_u32 s4, s4, s3
    s_addc_u32 s5, s5, 0
    s_mov_b32 s12, s4
    s_mov_b32 s13, s5
    s_mov_b32 s14, 4096
    s_mov_b32 s15, 0x00020000
    s_add_u32 s16, s4, 4194304
    s_addc_u32 s17, s5, 0
    s_mov_b32 s18, 4096
    s_mov_b32 s19, 0x00020000
    s_and_b32 s6, s2, 0xfffffffe
    s_lshl_b32 s6, s6, 1
    s_load_dword s28, s[26:27], s6
    v_lshlrev_b32 v2, 4, v0
    buffer_load_dwordx4 v[48:51], v2, s[12:15], 0 offen
    v_subrev_u32 v3, 80, v2
    v_subrev_u32 v4, 64, v2
    buffer_load_dwordx4 v[16:19], v3, s[8:11], 0 offen
    buffer_load_dwordx4 v[20:23], v4, s[8:11], 0 offen
    v_add_u32 v7, 4016, v2
    buffer_load_dwordx4 v[56:59], v7, s[8:11], 0 offen
    buffer_load_dwordx4 v[60:63], v7, s[8:11], 0 offen offset:16
    s_mov_b32 s38, 8388608
    s_mov_b32 s39, 0x00020000
    s_lshl_b32 s3, s2, 14
    buffer_load_dwordx4 v[96:99], v2, s[36:39], s3 offen
    s_add_u32 s3, s3, 4096
    buffer_load_dwordx4 v[100:103], v2, s[36:39], s3 offen
    s_add_u32 s3, s3, 4096
    buffer_load_dwordx4 v[104:107], v2, s[36:39], s3 offen
    s_add_u32 s3, s3, 4096
    buffer_load_dwordx4 v[108:111], v2, s[36:39], s3 offen
    s_add_u32 s3, s3, 4096
    v_lshrrev_b32 v5, 2, v0
    v_mul_u32_u24 v5, 80, v5
    v_and_b32 v6, 3, v0
    v_lshl_add_u32 v5, v6, 4, v5
    v_mov_b32 v52, 0
    v_mov_b32 v53, 0
    v_mov_b32 v54, 0
    v_mov_b32 v55, 0
    v_cmp_gt_u32 vcc, 124, v0
    s_and_saveexec_b64 s[30:31], vcc
    ds_write_b128 v5, v[52:55] offset:38400
    s_mov_b64 exec, s[30:31]
    s_waitcnt vmcnt(8)
    ds_write_b128 v5, v[48:51] offset:33280
    s_waitcnt vmcnt(6)
    v_mov_b32 v24, v17
    v_mov_b32 v25, v18
    v_mov_b32 v26, v19
    v_mov_b32 v27, v20
    v_mov_b32 v28, v21
    v_mov_b32 v29, v22
    v_alignbit_b32 v30, v17, v16, 16
    v_alignbit_b32 v31, v18, v17, 16
    v_alignbit_b32 v32, v19, v18, 16
    v_alignbit_b32 v33, v20, v19, 16
    v_alignbit_b32 v34, v21, v20, 16
    v_alignbit_b32 v35, v22, v21, 16
    v_alignbit_b32 v36, v23, v22, 16
    v_alignbit_b32 v38, v18, v17, 16
    v_alignbit_b32 v39, v19, v18, 16
    v_alignbit_b32 v40, v20, v19, 16
    v_alignbit_b32 v41, v21, v20, 16
    v_alignbit_b32 v42, v22, v21, 16
    v_alignbit_b32 v43, v23, v22, 16
    ds_write_b128 v2, v[30:33] offset:0
    ds_write_b128 v2, v[24:27] offset:4160
    ds_write_b128 v2, v[38:41] offset:8320
    ds_write_b128 v2, v[18:21] offset:12480
    ds_write_b128 v2, v[32:35] offset:16640
    ds_write_b128 v2, v[26:29] offset:20800
    ds_write_b128 v2, v[40:43] offset:24960
    ds_write_b128 v2, v[20:23] offset:29120
    v_add_u32 v7, 4096, v2
    s_waitcnt vmcnt(4)
    v_cmp_gt_u32 vcc, 4, v0
    s_and_saveexec_b64 s[30:31], vcc
    v_mov_b32 v24, v57
    v_mov_b32 v25, v58
    v_mov_b32 v26, v59
    v_mov_b32 v27, v60
    v_mov_b32 v28, v61
    v_mov_b32 v29, v62
    v_alignbit_b32 v30, v57, v56, 16
    v_alignbit_b32 v31, v58, v57, 16
    v_alignbit_b32 v32, v59, v58, 16
    v_alignbit_b32 v33, v60, v59, 16
    v_alignbit_b32 v34, v61, v60, 16
    v_alignbit_b32 v35, v62, v61, 16
    v_alignbit_b32 v36, v63, v62, 16
    v_alignbit_b32 v38, v58, v57, 16
    v_alignbit_b32 v39, v59, v58, 16
    v_alignbit_b32 v40, v60, v59, 16
    v_alignbit_b32 v41, v61, v60, 16
    v_alignbit_b32 v42, v62, v61, 16
    v_alignbit_b32 v43, v63, v62, 16
    ds_write_b128 v7, v[30:33] offset:0
    ds_write_b128 v7, v[24:27] offset:4160
    ds_write_b128 v7, v[38:41] offset:8320
    ds_write_b128 v7, v[58:61] offset:12480
    ds_write_b128 v7, v[32:35] offset:16640
    ds_write_b128 v7, v[26:29] offset:20800
    ds_write_b128 v7, v[40:43] offset:24960
    ds_write_b128 v7, v[60:63] offset:29120
    s_mov_b64 exec, s[30:31]
    v_and_b32 v1, 31, v0
    v_bfe_u32 v2, v0, 5, 1
    v_lshrrev_b32 v3, 6, v0
    v_and_b32 v4, 7, v1
    v_mul_u32_u24 v4, 4160, v4
    v_lshrrev_b32 v5, 3, v1
    v_add_u32 v5, v5, v2
    v_lshl_add_u32 v4, v5, 4, v4
    v_lshl_add_u32 v4, v3, 9, v4
    v_add_u32 v4, 16, v4
    v_sub_u32 v5, 31, v1
    v_mul_u32_u24 v5, 80, v5
    v_lshl_add_u32 v5, v2, 4, v5
    v_mul_u32_u24 v6, 640, v3
    v_add_u32 v5, v5, v6
    v_add_u32 v5, 33280, v5
    v_mov_b32 v64, 0
    v_mov_b32 v65, 0
    v_mov_b32 v66, 0
    v_mov_b32 v67, 0
    v_mov_b32 v68, 0
    v_mov_b32 v69, 0
    v_mov_b32 v70, 0
    v_mov_b32 v71, 0
    v_mov_b32 v72, 0
    v_mov_b32 v73, 0
    v_mov_b32 v74, 0
    v_mov_b32 v75, 0
    v_mov_b32 v76, 0
    v_mov_b32 v77, 0
    v_mov_b32 v78, 0
    v_mov_b32 v79, 0
    v_mov_b32 v80, 0
    v_mov_b32 v81, 0
    v_mov_b32 v82, 0
    v_mov_b32 v83, 0
    v_mov_b32 v84, 0
    v_mov_b32 v85, 0
    v_mov_b32 v86, 0
    v_mov_b32 v87, 0
    v_mov_b32 v88, 0
    v_mov_b32 v89, 0
    v_mov_b32 v90, 0
    v_mov_b32 v91, 0
    v_mov_b32 v92, 0
    v_mov_b32 v93, 0
    v_mov_b32 v94, 0
    v_mov_b32 v95, 0
    s_waitcnt lgkmcnt(0)
    s_barrier
    ds_read_b128 v[16:19], v4 offset:32
    ds_read_b128 v[20:23], v5 offset:2592
    ds_read_b128 v[24:27], v5 offset:32
    ds_read_b128 v[28:31], v4 offset:2080
    ds_read_b128 v[32:35], v4 offset:0
    ds_read_b128 v[36:39], v5 offset:2560
    ds_read_b128 v[40:43], v5 offset:0
    ds_read_b128 v[44:47], v4 offset:2048
    s_waitcnt lgkmcnt(4)
    v_mfma_f32_32x32x16_bf16 v[64:79], v[16:19], v[20:23], v[64:79]
    v_mfma_f32_32x32x16_bf16 v[80:95], v[16:19], v[24:27], v[80:95]
    v_mfma_f32_32x32x16_bf16 v[80:95], v[28:31], v[20:23], v[80:95]
    ds_read_b128 v[16:19], v4 offset:96
    ds_read_b128 v[20:23], v5 offset:2672
    ds_read_b128 v[24:27], v5 offset:112
    ds_read_b128 v[28:31], v4 offset:2144
    s_waitcnt lgkmcnt(4)
    v_mfma_f32_32x32x16_bf16 v[64:79], v[32:35], v[36:39], v[64:79]
    v_mfma_f32_32x32x16_bf16 v[80:95], v[32:35], v[40:43], v[80:95]
    v_mfma_f32_32x32x16_bf16 v[80:95], v[44:47], v[36:39], v[80:95]
    ds_read_b128 v[32:35], v4 offset:64
    ds_read_b128 v[36:39], v5 offset:2640
    ds_read_b128 v[40:43], v5 offset:80
    ds_read_b128 v[44:47], v4 offset:2112
    s_waitcnt lgkmcnt(4)
    v_mfma_f32_32x32x16_bf16 v[64:79], v[16:19], v[20:23], v[64:79]
    v_mfma_f32_32x32x16_bf16 v[80:95], v[16:19], v[24:27], v[80:95]
    v_mfma_f32_32x32x16_bf16 v[80:95], v[28:31], v[20:23], v[80:95]
    ds_read_b128 v[16:19], v4 offset:160
    ds_read_b128 v[20:23], v5 offset:2752
    ds_read_b128 v[24:27], v5 offset:192
    ds_read_b128 v[28:31], v4 offset:2208
    s_waitcnt lgkmcnt(4)
    v_mfma_f32_32x32x16_bf16 v[64:79], v[32:35], v[36:39], v[64:79]
    v_mfma_f32_32x32x16_bf16 v[80:95], v[32:35], v[40:43], v[80:95]
    v_mfma_f32_32x32x16_bf16 v[80:95], v[44:47], v[36:39], v[80:95]
    ds_read_b128 v[32:35], v4 offset:128
    ds_read_b128 v[36:39], v5 offset:2720
    ds_read_b128 v[40:43], v5 offset:160
    ds_read_b128 v[44:47], v4 offset:2176
    s_waitcnt lgkmcnt(4)
    v_mfma_f32_32x32x16_bf16 v[64:79], v[16:19], v[20:23], v[64:79]
    v_mfma_f32_32x32x16_bf16 v[80:95], v[16:19], v[24:27], v[80:95]
    v_mfma_f32_32x32x16_bf16 v[80:95], v[28:31], v[20:23], v[80:95]
    ds_read_b128 v[16:19], v4 offset:224
    ds_read_b128 v[20:23], v5 offset:2832
    ds_read_b128 v[24:27], v5 offset:272
    ds_read_b128 v[28:31], v4 offset:2272
    s_waitcnt lgkmcnt(4)
    v_mfma_f32_32x32x16_bf16 v[64:79], v[32:35], v[36:39], v[64:79]
    v_mfma_f32_32x32x16_bf16 v[80:95], v[32:35], v[40:43], v[80:95]
    v_mfma_f32_32x32x16_bf16 v[80:95], v[44:47], v[36:39], v[80:95]
    ds_read_b128 v[32:35], v4 offset:192
    ds_read_b128 v[36:39], v5 offset:2800
    ds_read_b128 v[40:43], v5 offset:240
    ds_read_b128 v[44:47], v4 offset:2240
    s_waitcnt lgkmcnt(4)
    v_mfma_f32_32x32x16_bf16 v[64:79], v[16:19], v[20:23], v[64:79]
    v_mfma_f32_32x32x16_bf16 v[80:95], v[16:19], v[24:27], v[80:95]
    v_mfma_f32_32x32x16_bf16 v[80:95], v[28:31], v[20:23], v[80:95]
    ds_read_b128 v[16:19], v4 offset:288
    ds_read_b128 v[20:23], v5 offset:2912
    ds_read_b128 v[24:27], v5 offset:352
    ds_read_b128 v[28:31], v4 offset:2336
    s_waitcnt lgkmcnt(4)
    v_mfma_f32_32x32x16_bf16 v[64:79], v[32:35], v[36:39], v[64:79]
    v_mfma_f32_32x32x16_bf16 v[80:95], v[32:35], v[40:43], v[80:95]
    v_mfma_f32_32x32x16_bf16 v[80:95], v[44:47], v[36:39], v[80:95]
    ds_read_b128 v[32:35], v4 offset:256
    ds_read_b128 v[36:39], v5 offset:2880
    ds_read_b128 v[40:43], v5 offset:320
    ds_read_b128 v[44:47], v4 offset:2304
    s_waitcnt lgkmcnt(4)
    v_mfma_f32_32x32x16_bf16 v[64:79], v[16:19], v[20:23], v[64:79]
    v_mfma_f32_32x32x16_bf16 v[80:95], v[16:19], v[24:27], v[80:95]
    v_mfma_f32_32x32x16_bf16 v[80:95], v[28:31], v[20:23], v[80:95]
    ds_read_b128 v[16:19], v4 offset:352
    ds_read_b128 v[20:23], v5 offset:2992
    ds_read_b128 v[24:27], v5 offset:432
    ds_read_b128 v[28:31], v4 offset:2400
    s_waitcnt lgkmcnt(4)
    v_mfma_f32_32x32x16_bf16 v[64:79], v[32:35], v[36:39], v[64:79]
    v_mfma_f32_32x32x16_bf16 v[80:95], v[32:35], v[40:43], v[80:95]
    v_mfma_f32_32x32x16_bf16 v[80:95], v[44:47], v[36:39], v[80:95]
    ds_read_b128 v[32:35], v4 offset:320
    ds_read_b128 v[36:39], v5 offset:2960
    ds_read_b128 v[40:43], v5 offset:400
    ds_read_b128 v[44:47], v4 offset:2368
    s_waitcnt lgkmcnt(4)
    v_mfma_f32_32x32x16_bf16 v[64:79], v[16:19], v[20:23], v[64:79]
    v_mfma_f32_32x32x16_bf16 v[80:95], v[16:19], v[24:27], v[80:95]
    v_mfma_f32_32x32x16_bf16 v[80:95], v[28:31], v[20:23], v[80:95]
    ds_read_b128 v[16:19], v4 offset:416
    ds_read_b128 v[20:23], v5 offset:3072
    ds_read_b128 v[24:27], v5 offset:512
    ds_read_b128 v[28:31], v4 offset:2464
    s_waitcnt lgkmcnt(4)
    v_mfma_f32_32x32x16_bf16 v[64:79], v[32:35], v[36:39], v[64:79]
    v_mfma_f32_32x32x16_bf16 v[80:95], v[32:35], v[40:43], v[80:95]
    v_mfma_f32_32x32x16_bf16 v[80:95], v[44:47], v[36:39], v[80:95]
    ds_read_b128 v[32:35], v4 offset:384
    ds_read_b128 v[36:39], v5 offset:3040
    ds_read_b128 v[40:43], v5 offset:480
    ds_read_b128 v[44:47], v4 offset:2432
    s_waitcnt lgkmcnt(4)
    v_mfma_f32_32x32x16_bf16 v[64:79], v[16:19], v[20:23], v[64:79]
    v_mfma_f32_32x32x16_bf16 v[80:95], v[16:19], v[24:27], v[80:95]
    v_mfma_f32_32x32x16_bf16 v[80:95], v[28:31], v[20:23], v[80:95]
    ds_read_b128 v[16:19], v4 offset:480
    ds_read_b128 v[20:23], v5 offset:3152
    ds_read_b128 v[24:27], v5 offset:592
    ds_read_b128 v[28:31], v4 offset:2528
    s_waitcnt lgkmcnt(4)
    v_mfma_f32_32x32x16_bf16 v[64:79], v[32:35], v[36:39], v[64:79]
    v_mfma_f32_32x32x16_bf16 v[80:95], v[32:35], v[40:43], v[80:95]
    v_mfma_f32_32x32x16_bf16 v[80:95], v[44:47], v[36:39], v[80:95]
    ds_read_b128 v[32:35], v4 offset:448
    ds_read_b128 v[36:39], v5 offset:3120
    ds_read_b128 v[40:43], v5 offset:560
    ds_read_b128 v[44:47], v4 offset:2496
    s_waitcnt lgkmcnt(4)
    v_mfma_f32_32x32x16_bf16 v[64:79], v[16:19], v[20:23], v[64:79]
    v_mfma_f32_32x32x16_bf16 v[80:95], v[16:19], v[24:27], v[80:95]
    v_mfma_f32_32x32x16_bf16 v[80:95], v[28:31], v[20:23], v[80:95]
    s_waitcnt lgkmcnt(0)
    v_mfma_f32_32x32x16_bf16 v[64:79], v[32:35], v[36:39], v[64:79]
    v_mfma_f32_32x32x16_bf16 v[80:95], v[32:35], v[40:43], v[80:95]
    v_mfma_f32_32x32x16_bf16 v[80:95], v[44:47], v[36:39], v[80:95]
    s_nop 15
    s_barrier
    v_and_b32 v6, 63, v0
    v_lshlrev_b32 v6, 4, v6
    v_lshl_add_u32 v7, v3, 13, v6
    ds_write_b128 v7, v[64:67] offset:0
    ds_write_b128 v7, v[68:71] offset:1024
    ds_write_b128 v7, v[72:75] offset:2048
    ds_write_b128 v7, v[76:79] offset:3072
    ds_write_b128 v7, v[80:83] offset:4096
    ds_write_b128 v7, v[84:87] offset:5120
    ds_write_b128 v7, v[88:91] offset:6144
    ds_write_b128 v7, v[92:95] offset:7168
    v_lshl_add_u32 v8, v3, 11, v6
    s_waitcnt lgkmcnt(0)
    s_barrier
    ds_read_b128 v[16:19], v8 offset:0
    ds_read_b128 v[20:23], v8 offset:1024
    ds_read_b128 v[24:27], v8 offset:8192
    ds_read_b128 v[28:31], v8 offset:9216
    ds_read_b128 v[32:35], v8 offset:16384
    ds_read_b128 v[36:39], v8 offset:17408
    ds_read_b128 v[40:43], v8 offset:24576
    ds_read_b128 v[44:47], v8 offset:25600
    v_lshrrev_b32 v9, 1, v3
    v_lshlrev_b32 v9, 10, v9
    v_lshl_add_u32 v9, v1, 5, v9
    v_and_b32 v10, 1, v3
    v_lshl_add_u32 v9, v10, 4, v9
    v_lshl_add_u32 v9, v2, 2, v9
    v_sub_u32 v10, 2044, v9
    v_lshrrev_b32 v11, 5, v10
    v_mul_u32_u24 v11, 80, v11
    v_and_b32 v10, 31, v10
    v_lshl_add_u32 v11, v10, 1, v11
    ds_read_b64 v[48:49], v11 offset:33280
    v_sub_u32 v10, 2036, v9
    v_lshrrev_b32 v11, 5, v10
    v_mul_u32_u24 v11, 80, v11
    v_and_b32 v10, 31, v10
    v_lshl_add_u32 v11, v10, 1, v11
    ds_read_b64 v[50:51], v11 offset:33280
    s_and_b32 s6, s2, 1
    s_cmp_eq_u32 s6, 1
    s_cbranch_scc1 L_conv_odd
    s_lshl_b32 s28, s28, 16
L_conv_odd:
    s_and_b32 s28, s28, 0xffff0000
    s_waitcnt lgkmcnt(0)
    v_add_f32 v16, v16, v24
    v_add_f32 v16, v16, v32
    v_add_f32 v16, v16, v40
    v_add_f32 v17, v17, v25
    v_add_f32 v17, v17, v33
    v_add_f32 v17, v17, v41
    v_add_f32 v18, v18, v26
    v_add_f32 v18, v18, v34
    v_add_f32 v18, v18, v42
    v_add_f32 v19, v19, v27
    v_add_f32 v19, v19, v35
    v_add_f32 v19, v19, v43
    v_add_f32 v20, v20, v28
    v_add_f32 v20, v20, v36
    v_add_f32 v20, v20, v44
    v_add_f32 v21, v21, v29
    v_add_f32 v21, v21, v37
    v_add_f32 v21, v21, v45
    v_add_f32 v22, v22, v30
    v_add_f32 v22, v22, v38
    v_add_f32 v22, v22, v46
    v_add_f32 v23, v23, v31
    v_add_f32 v23, v23, v39
    v_add_f32 v23, v23, v47
    v_cvt_pk_bf16_f32 v60, v16, v17
    v_lshlrev_b32 v16, 16, v60
    v_and_b32 v17, 0xffff0000, v60
    v_cvt_pk_bf16_f32 v60, v18, v19
    v_lshlrev_b32 v18, 16, v60
    v_and_b32 v19, 0xffff0000, v60
    v_lshlrev_b32 v55, 16, v48
    v_and_b32 v54, 0xffff0000, v48
    v_lshlrev_b32 v53, 16, v49
    v_and_b32 v52, 0xffff0000, v49
    v_mul_f32 v52, s28, v52
    v_mul_f32 v53, s28, v53
    v_mul_f32 v54, s28, v54
    v_mul_f32 v55, s28, v55
    v_cvt_pk_bf16_f32 v60, v52, v53
    v_lshlrev_b32 v52, 16, v60
    v_and_b32 v53, 0xffff0000, v60
    v_cvt_pk_bf16_f32 v60, v54, v55
    v_lshlrev_b32 v54, 16, v60
    v_and_b32 v55, 0xffff0000, v60
    v_add_f32 v16, v16, v52
    v_add_f32 v17, v17, v53
    v_add_f32 v18, v18, v54
    v_add_f32 v19, v19, v55
    v_cvt_pk_bf16_f32 v56, v16, v17
    v_cvt_pk_bf16_f32 v57, v18, v19
    v_cvt_pk_bf16_f32 v60, v20, v21
    v_lshlrev_b32 v20, 16, v60
    v_and_b32 v21, 0xffff0000, v60
    v_cvt_pk_bf16_f32 v60, v22, v23
    v_lshlrev_b32 v22, 16, v60
    v_and_b32 v23, 0xffff0000, v60
    v_lshlrev_b32 v55, 16, v50
    v_and_b32 v54, 0xffff0000, v50
    v_lshlrev_b32 v53, 16, v51
    v_and_b32 v52, 0xffff0000, v51
    v_mul_f32 v52, s28, v52
    v_mul_f32 v53, s28, v53
    v_mul_f32 v54, s28, v54
    v_mul_f32 v55, s28, v55
    v_cvt_pk_bf16_f32 v60, v52, v53
    v_lshlrev_b32 v52, 16, v60
    v_and_b32 v53, 0xffff0000, v60
    v_cvt_pk_bf16_f32 v60, v54, v55
    v_lshlrev_b32 v54, 16, v60
    v_and_b32 v55, 0xffff0000, v60
    v_add_f32 v20, v20, v52
    v_add_f32 v21, v21, v53
    v_add_f32 v22, v22, v54
    v_add_f32 v23, v23, v55
    v_cvt_pk_bf16_f32 v58, v20, v21
    v_cvt_pk_bf16_f32 v59, v22, v23
    v_lshlrev_b32 v9, 1, v9
    buffer_store_dwordx2 v[56:57], v9, s[16:19], 0 offen
    buffer_store_dwordx2 v[58:59], v9, s[16:19], 0 offen offset:16
    s_branch L_conv_end
L_cw_w:
    s_cmp_ge_u32 s2, 730
    s_cbranch_scc1 L_cw_touch
    s_load_dwordx2 s[4:5], s[0:1], 104
    s_mov_b32 s30, 0x05040100
    s_mov_b32 s31, 0x07060302
    s_cmp_lt_u32 s2, 700
    s_cbranch_scc0 L_cw_c
    s_load_dwordx2 s[24:25], s[0:1], 56
    s_sub_u32 s3, s2, 640
    s_lshl_b32 s3, s3, 10
    v_add_u32 v1, s3, v0
    v_lshrrev_b32 v2, 8, v1
    v_mul_u32_u24 v2, 21846, v2
    v_lshrrev_b32 v2, 16, v2
    v_mul_u32_u24 v3, 768, v2
    v_sub_u32 v1, v1, v3
    s_add_u32 s3, s3, 256
    v_add_u32 v5, s3, v0
    v_lshrrev_b32 v6, 8, v5
    v_mul_u32_u24 v6, 21846, v6
    v_lshrrev_b32 v6, 16, v6
    v_mul_u32_u24 v7, 768, v6
    v_sub_u32 v5, v5, v7
    s_add_u32 s3, s3, 256
    v_add_u32 v9, s3, v0
    v_lshrrev_b32 v10, 8, v9
    v_mul_u32_u24 v10, 21846, v10
    v_lshrrev_b32 v10, 16, v10
    v_mul_u32_u24 v11, 768, v10
    v_sub_u32 v9, v9, v11
    s_add_u32 s3, s3, 256
    v_add_u32 v13, s3, v0
    v_lshrrev_b32 v14, 8, v13
    v_mul_u32_u24 v14, 21846, v14
    v_lshrrev_b32 v14, 16, v14
    v_mul_u32_u24 v15, 768, v14
    v_sub_u32 v13, v13, v15
    s_add_u32 s3, s3, 256
    s_waitcnt lgkmcnt(0)
    s_mov_b32 s8, s24
    s_mov_b32 s9, s25
    s_mov_b32 s10, 1966080
    s_mov_b32 s11, 0x00020000
    s_add_u32 s20, s4, 8388608
    s_addc_u32 s21, s5, 0
    s_mov_b32 s22, 1966080
    s_mov_b32 s23, 0x00020000
    s_mov_b32 s34, 3072
    s_mov_b32 s35, 1536
    s_branch L_cw_wc
L_cw_c:
    s_load_dwordx2 s[24:25], s[0:1], 80
    s_sub_u32 s3, s2, 700
    s_lshl_b32 s3, s3, 10
    v_add_u32 v1, s3, v0
    v_mul_u32_u24 v2, 52429, v1
    v_lshrrev_b32 v2, 24, v2
    v_mul_u32_u24 v3, 320, v2
    v_sub_u32 v1, v1, v3
    s_add_u32 s3, s3, 256
    v_add_u32 v5, s3, v0
    v_mul_u32_u24 v6, 52429, v5
    v_lshrrev_b32 v6, 24, v6
    v_mul_u32_u24 v7, 320, v6
    v_sub_u32 v5, v5, v7
    s_add_u32 s3, s3, 256
    v_add_u32 v9, s3, v0
    v_mul_u32_u24 v10, 52429, v9
    v_lshrrev_b32 v10, 24, v10
    v_mul_u32_u24 v11, 320, v10
    v_sub_u32 v9, v9, v11
    s_add_u32 s3, s3, 256
    v_add_u32 v13, s3, v0
    v_mul_u32_u24 v14, 52429, v13
    v_lshrrev_b32 v14, 24, v14
    v_mul_u32_u24 v15, 320, v14
    v_sub_u32 v13, v13, v15
    s_add_u32 s3, s3, 256
    s_waitcnt lgkmcnt(0)
    s_mov_b32 s8, s24
    s_mov_b32 s9, s25
    s_mov_b32 s10, 983040
    s_mov_b32 s11, 0x00020000
    s_add_u32 s20, s4, 12582912
    s_addc_u32 s21, s5, 0
    s_mov_b32 s22, 983040
    s_mov_b32 s23, 0x00020000
    s_mov_b32 s34, 1280
    s_mov_b32 s35, 640
L_cw_wc:
    v_lshlrev_b32 v3, 3, v2
    v_mul_lo_u32 v3, v3, s34
    v_lshl_add_u32 v3, v1, 2, v3
    buffer_load_dword v24, v3, s[8:11], 0 offen
    v_add_u32 v3, s34, v3
    buffer_load_dword v25, v3, s[8:11], 0 offen
    v_add_u32 v3, s34, v3
    buffer_load_dword v26, v3, s[8:11], 0 offen
    v_add_u32 v3, s34, v3
    buffer_load_dword v27, v3, s[8:11], 0 offen
    v_add_u32 v3, s34, v3
    buffer_load_dword v28, v3, s[8:11], 0 offen
    v_add_u32 v3, s34, v3
    buffer_load_dword v29, v3, s[8:11], 0 offen
    v_add_u32 v3, s34, v3
    buffer_load_dword v30, v3, s[8:11], 0 offen
    v_add_u32 v3, s34, v3
    buffer_load_dword v31, v3, s[8:11], 0 offen
    v_mul_lo_u32 v4, v2, s35
    v_lshl_add_u32 v4, v1, 1, v4
    v_lshlrev_b32 v4, 4, v4
    v_lshlrev_b32 v7, 3, v6
    v_mul_lo_u32 v7, v7, s34
    v_lshl_add_u32 v7, v5, 2, v7
    buffer_load_dword v32, v7, s[8:11], 0 offen
    v_add_u32 v7, s34, v7
    buffer_load_dword v33, v7, s[8:11], 0 offen
    v_add_u32 v7, s34, v7
    buffer_load_dword v34, v7, s[8:11], 0 offen
    v_add_u32 v7, s34, v7
    buffer_load_dword v35, v7, s[8:11], 0 offen
    v_add_u32 v7, s34, v7
    buffer_load_dword v36, v7, s[8:11], 0 offen
    v_add_u32 v7, s34, v7
    buffer_load_dword v37, v7, s[8:11], 0 offen
    v_add_u32 v7, s34, v7
    buffer_load_dword v38, v7, s[8:11], 0 offen
    v_add_u32 v7, s34, v7
    buffer_load_dword v39, v7, s[8:11], 0 offen
    v_mul_lo_u32 v8, v6, s35
    v_lshl_add_u32 v8, v5, 1, v8
    v_lshlrev_b32 v8, 4, v8
    v_lshlrev_b32 v11, 3, v10
    v_mul_lo_u32 v11, v11, s34
    v_lshl_add_u32 v11, v9, 2, v11
    buffer_load_dword v40, v11, s[8:11], 0 offen
    v_add_u32 v11, s34, v11
    buffer_load_dword v41, v11, s[8:11], 0 offen
    v_add_u32 v11, s34, v11
    buffer_load_dword v42, v11, s[8:11], 0 offen
    v_add_u32 v11, s34, v11
    buffer_load_dword v43, v11, s[8:11], 0 offen
    v_add_u32 v11, s34, v11
    buffer_load_dword v44, v11, s[8:11], 0 offen
    v_add_u32 v11, s34, v11
    buffer_load_dword v45, v11, s[8:11], 0 offen
    v_add_u32 v11, s34, v11
    buffer_load_dword v46, v11, s[8:11], 0 offen
    v_add_u32 v11, s34, v11
    buffer_load_dword v47, v11, s[8:11], 0 offen
    v_mul_lo_u32 v12, v10, s35
    v_lshl_add_u32 v12, v9, 1, v12
    v_lshlrev_b32 v12, 4, v12
    v_lshlrev_b32 v15, 3, v14
    v_mul_lo_u32 v15, v15, s34
    v_lshl_add_u32 v15, v13, 2, v15
    buffer_load_dword v48, v15, s[8:11], 0 offen
    v_add_u32 v15, s34, v15
    buffer_load_dword v49, v15, s[8:11], 0 offen
    v_add_u32 v15, s34, v15
    buffer_load_dword v50, v15, s[8:11], 0 offen
    v_add_u32 v15, s34, v15
    buffer_load_dword v51, v15, s[8:11], 0 offen
    v_add_u32 v15, s34, v15
    buffer_load_dword v52, v15, s[8:11], 0 offen
    v_add_u32 v15, s34, v15
    buffer_load_dword v53, v15, s[8:11], 0 offen
    v_add_u32 v15, s34, v15
    buffer_load_dword v54, v15, s[8:11], 0 offen
    v_add_u32 v15, s34, v15
    buffer_load_dword v55, v15, s[8:11], 0 offen
    v_mul_lo_u32 v16, v14, s35
    v_lshl_add_u32 v16, v13, 1, v16
    v_lshlrev_b32 v16, 4, v16
    s_waitcnt vmcnt(24)
    v_perm_b32 v60, v25, v24, s30
    v_perm_b32 v64, v25, v24, s31
    v_perm_b32 v61, v27, v26, s30
    v_perm_b32 v65, v27, v26, s31
    v_perm_b32 v62, v29, v28, s30
    v_perm_b32 v66, v29, v28, s31
    v_perm_b32 v63, v31, v30, s30
    v_perm_b32 v67, v31, v30, s31
    buffer_store_dwordx4 v[60:63], v4, s[20:23], 0 offen
    buffer_store_dwordx4 v[64:67], v4, s[20:23], 0 offen offset:16
    s_waitcnt vmcnt(18)
    v_perm_b32 v68, v33, v32, s30
    v_perm_b32 v72, v33, v32, s31
    v_perm_b32 v69, v35, v34, s30
    v_perm_b32 v73, v35, v34, s31
    v_perm_b32 v70, v37, v36, s30
    v_perm_b32 v74, v37, v36, s31
    v_perm_b32 v71, v39, v38, s30
    v_perm_b32 v75, v39, v38, s31
    buffer_store_dwordx4 v[68:71], v8, s[20:23], 0 offen
    buffer_store_dwordx4 v[72:75], v8, s[20:23], 0 offen offset:16
    s_waitcnt vmcnt(12)
    v_perm_b32 v76, v41, v40, s30
    v_perm_b32 v80, v41, v40, s31
    v_perm_b32 v77, v43, v42, s30
    v_perm_b32 v81, v43, v42, s31
    v_perm_b32 v78, v45, v44, s30
    v_perm_b32 v82, v45, v44, s31
    v_perm_b32 v79, v47, v46, s30
    v_perm_b32 v83, v47, v46, s31
    buffer_store_dwordx4 v[76:79], v12, s[20:23], 0 offen
    buffer_store_dwordx4 v[80:83], v12, s[20:23], 0 offen offset:16
    s_waitcnt vmcnt(6)
    v_perm_b32 v84, v49, v48, s30
    v_perm_b32 v88, v49, v48, s31
    v_perm_b32 v85, v51, v50, s30
    v_perm_b32 v89, v51, v50, s31
    v_perm_b32 v86, v53, v52, s30
    v_perm_b32 v90, v53, v52, s31
    v_perm_b32 v87, v55, v54, s30
    v_perm_b32 v91, v55, v54, s31
    buffer_store_dwordx4 v[84:87], v16, s[20:23], 0 offen
    buffer_store_dwordx4 v[88:91], v16, s[20:23], 0 offen offset:16
    s_branch L_conv_end
L_cw_touch:
    s_sub_u32 s3, s2, 730
    s_load_dwordx2 s[8:9], s[0:1], 0
    s_mul_i32 s3, s3, 98304
    v_lshlrev_b32 v1, 4, v0
    s_mov_b32 s10, 2621440
    s_mov_b32 s11, 0x00020000
    s_waitcnt lgkmcnt(0)
    buffer_load_dwordx4 v[8:11], v1, s[8:11], s3 offen
    s_add_u32 s3, s3, 4096
    buffer_load_dwordx4 v[12:15], v1, s[8:11], s3 offen
    s_add_u32 s3, s3, 4096
    buffer_load_dwordx4 v[16:19], v1, s[8:11], s3 offen
    s_add_u32 s3, s3, 4096
    buffer_load_dwordx4 v[20:23], v1, s[8:11], s3 offen
    s_add_u32 s3, s3, 4096
    buffer_load_dwordx4 v[24:27], v1, s[8:11], s3 offen
    s_add_u32 s3, s3, 4096
    buffer_load_dwordx4 v[28:31], v1, s[8:11], s3 offen
    s_add_u32 s3, s3, 4096
    buffer_load_dwordx4 v[32:35], v1, s[8:11], s3 offen
    s_add_u32 s3, s3, 4096
    buffer_load_dwordx4 v[36:39], v1, s[8:11], s3 offen
    s_add_u32 s3, s3, 4096
    buffer_load_dwordx4 v[40:43], v1, s[8:11], s3 offen
    s_add_u32 s3, s3, 4096
    buffer_load_dwordx4 v[44:47], v1, s[8:11], s3 offen
    s_add_u32 s3, s3, 4096
    buffer_load_dwordx4 v[48:51], v1, s[8:11], s3 offen
    s_add_u32 s3, s3, 4096
    buffer_load_dwordx4 v[52:55], v1, s[8:11], s3 offen
    s_add_u32 s3, s3, 4096
    buffer_load_dwordx4 v[56:59], v1, s[8:11], s3 offen
    s_add_u32 s3, s3, 4096
    buffer_load_dwordx4 v[60:63], v1, s[8:11], s3 offen
    s_add_u32 s3, s3, 4096
    buffer_load_dwordx4 v[64:67], v1, s[8:11], s3 offen
    s_add_u32 s3, s3, 4096
    buffer_load_dwordx4 v[68:71], v1, s[8:11], s3 offen
    s_add_u32 s3, s3, 4096
    buffer_load_dwordx4 v[72:75], v1, s[8:11], s3 offen
    s_add_u32 s3, s3, 4096
    buffer_load_dwordx4 v[76:79], v1, s[8:11], s3 offen
    s_add_u32 s3, s3, 4096
    buffer_load_dwordx4 v[80:83], v1, s[8:11], s3 offen
    s_add_u32 s3, s3, 4096
    buffer_load_dwordx4 v[84:87], v1, s[8:11], s3 offen
    s_add_u32 s3, s3, 4096
    buffer_load_dwordx4 v[88:91], v1, s[8:11], s3 offen
    s_add_u32 s3, s3, 4096
    buffer_load_dwordx4 v[92:95], v1, s[8:11], s3 offen
    s_add_u32 s3, s3, 4096
    buffer_load_dwordx4 v[96:99], v1, s[8:11], s3 offen
    s_add_u32 s3, s3, 4096
    buffer_load_dwordx4 v[100:103], v1, s[8:11], s3 offen
    s_add_u32 s3, s3, 4096
L_conv_end:
    s_endpgm
.globl lnx0_kernel
.p2align 8
.type lnx0_kernel,@function
lnx0_kernel:
    s_cmp_ge_u32 s2, 256
    s_cbranch_scc1 L_lnx0_kernel_end
    s_cmp_ge_u32 s2, 8
    s_cbranch_scc1 L_cpf_2
    v_lshlrev_b32 v1, 4, v0
    s_getpc_b64 s[100:101]
L_cpfpc_2_0:
    s_add_u32 s100, s100, gemm1_0_kernel-L_cpfpc_2_0
    s_addc_u32 s101, s101, (gemm1_0_kernel-L_cpfpc_2_0)>>32
    v_cmp_gt_u32 vcc, L_text_end-gemm1_0_kernel-16, v1
    s_and_saveexec_b64 s[98:99], vcc
    global_load_dwordx4 v[92:95], v1, s[100:101]
    s_mov_b64 exec, s[98:99]
L_cpf_2:
    s_load_dwordx2 s[4:5], s[0:1], 104
    s_load_dwordx2 s[6:7], s[0:1], 0
    s_and_b32 s3, s2, 7
    s_lshl_b32 s3, s3, 5
    s_lshr_b32 s2, s2, 3
    s_add_u32 s2, s2, s3
    v_and_b32 v1, 63, v0
    v_lshrrev_b32 v2, 6, v0
    s_lshl_b32 s3, s2, 3
    s_lshl_b32 s24, s2, 4
    v_mul_u32_u24 v3, 4224, v0
    v_add_u32 v4, 2162688, v3
    v_add_u32 v5, s3, v2
    v_mul_u32_u24 v8, 1280, v5
    v_lshl_add_u32 v6, v1, 4, v8
    v_lshl_add_u32 v8, v1, 2, v8
    s_waitcnt lgkmcnt(0)
    s_mov_b32 s8, s6
    s_mov_b32 s9, s7
    s_mov_b32 s10, 2621440
    s_mov_b32 s11, 0x00020000
    s_add_u32 s12, s4, 4194304
    s_addc_u32 s13, s5, 0
    s_mov_b32 s14, 2703360
    s_mov_b32 s15, 0x00020000
    buffer_load_dwordx4 v[48:51], v6, s[8:11], 0 offen
    buffer_load_dword v52, v8, s[8:11], 0 offen offset:1024
    buffer_load_dwordx4 v[40:43], v3, s[12:15], s24 offen
    buffer_load_dwordx4 v[44:47], v4, s[12:15], s24 offen
    s_add_u32 s24, s4, 46137344
    s_addc_u32 s25, s5, 0
    s_mov_b32 s26, 2621440
    s_mov_b32 s27, 0x00020000
    s_add_u32 s16, s4, 16777216
    s_addc_u32 s17, s5, 0
    s_mov_b32 s18, 2621440
    s_mov_b32 s19, 0x00020000
    s_add_u32 s20, s4, 20971520
    s_addc_u32 s21, s5, 0
    s_mov_b32 s22, 2621440
    s_mov_b32 s23, 0x00020000
    s_waitcnt vmcnt(2)
    v_lshlrev_b32 v60, 16, v48
    v_and_b32 v61, 0xffff0000, v48
    v_lshlrev_b32 v62, 16, v49
    v_and_b32 v63, 0xffff0000, v49
    v_lshlrev_b32 v64, 16, v50
    v_and_b32 v65, 0xffff0000, v50
    v_lshlrev_b32 v66, 16, v51
    v_and_b32 v67, 0xffff0000, v51
    v_lshlrev_b32 v68, 16, v52
    v_and_b32 v69, 0xffff0000, v52
    v_pk_add_f32 v[10:11], v[60:61], v[62:63]
    v_pk_add_f32 v[10:11], v[10:11], v[64:65]
    v_pk_add_f32 v[10:11], v[10:11], v[66:67]
    v_pk_add_f32 v[10:11], v[10:11], v[68:69]
    v_add_f32 v10, v10, v11
    s_nop 1
    v_add_f32_dpp v10, v10, v10 row_shr:1 row_mask:0xf bank_mask:0xf bound_ctrl:0
    s_nop 1
    v_add_f32_dpp v10, v10, v10 row_shr:2 row_mask:0xf bank_mask:0xf bound_ctrl:0
    s_nop 1
    v_add_f32_dpp v10, v10, v10 row_shr:4 row_mask:0xf bank_mask:0xf bound_ctrl:0
    s_nop 1
    v_add_f32_dpp v10, v10, v10 row_shr:8 row_mask:0xf bank_mask:0xf bound_ctrl:0
    s_nop 1
    v_add_f32_dpp v10, v10, v10 row_bcast:15 row_mask:0xa bank_mask:0xf
    s_nop 1
    v_add_f32_dpp v10, v10, v10 row_bcast:31 row_mask:0xc bank_mask:0xf
    s_nop 1
    v_readlane_b32 s40, v10, 63
    s_nop 1
    v_mov_b32 v10, s40
    v_mul_f32 v10, -0.0015625, v10
    v_mov_b32 v11, v10
    v_pk_add_f32 v[12:13], v[60:61], v[10:11]
    v_pk_mul_f32 v[14:15], v[12:13], v[12:13]
    v_pk_add_f32 v[12:13], v[62:63], v[10:11]
    v_pk_fma_f32 v[14:15], v[12:13], v[12:13], v[14:15]
    v_pk_add_f32 v[12:13], v[64:65], v[10:11]
    v_pk_fma_f32 v[14:15], v[12:13], v[12:13], v[14:15]
    v_pk_add_f32 v[12:13], v[66:67], v[10:11]
    v_pk_fma_f32 v[14:15], v[12:13], v[12:13], v[14:15]
    v_pk_add_f32 v[12:13], v[68:69], v[10:11]
    v_pk_fma_f32 v[14:15], v[12:13], v[12:13], v[14:15]
    v_add_f32 v12, v14, v15
    s_nop 1
    v_add_f32_dpp v12, v12, v12 row_shr:1 row_mask:0xf bank_mask:0xf bound_ctrl:0
    s_nop 1
    v_add_f32_dpp v12, v12, v12 row_shr:2 row_mask:0xf bank_mask:0xf bound_ctrl:0
    s_nop 1
    v_add_f32_dpp v12, v12, v12 row_shr:4 row_mask:0xf bank_mask:0xf bound_ctrl:0
    s_nop 1
    v_add_f32_dpp v12, v12, v12 row_shr:8 row_mask:0xf bank_mask:0xf bound_ctrl:0
    s_nop 1
    v_add_f32_dpp v12, v12, v12 row_bcast:15 row_mask:0xa bank_mask:0xf
    s_nop 1
    v_add_f32_dpp v12, v12, v12 row_bcast:31 row_mask:0xc bank_mask:0xf
    s_nop 1
    v_readlane_b32 s41, v12, 63
    s_nop 1
    v_mov_b32 v11, s41
    v_mul_f32 v11, 0.0015625, v11
    v_cvt_pk_bf16_f32 v12, v10, v11
    v_lshlrev_b32 v10, 16, v12
    v_and_b32 v11, 0xffff0000, v12
    v_add_f32 v11, 0x3727c5ac, v11
    v_cvt_pk_bf16_f32 v12, v11, v11
    v_lshlrev_b32 v11, 16, v12
    v_and_b32 v11, 0xffff0000, v12
    v_sqrt_f32 v11, v11
    s_nop 0
    v_cvt_pk_bf16_f32 v12, v11, v11
    v_lshlrev_b32 v11, 16, v12
    v_and_b32 v11, 0xffff0000, v12
    v_rcp_f32 v12, v11
    v_mov_b32 v11, v10
    v_mov_b32 v13, v12
    v_pk_add_f32 v[100:101], v[60:61], v[10:11]
    v_cvt_pk_bf16_f32 v16, v100, v101
    v_lshlrev_b32 v100, 16, v16
    v_and_b32 v101, 0xffff0000, v16
    v_pk_mul_f32 v[100:101], v[100:101], v[12:13]
    v_cvt_pk_bf16_f32 v16, v100, v101
    v_lshlrev_b32 v100, 16, v16
    v_and_b32 v101, 0xffff0000, v16
    v_pk_add_f32 v[102:103], v[62:63], v[10:11]
    v_cvt_pk_bf16_f32 v16, v102, v103
    v_lshlrev_b32 v102, 16, v16
    v_and_b32 v103, 0xffff0000, v16
    v_pk_mul_f32 v[102:103], v[102:103], v[12:13]
    v_cvt_pk_bf16_f32 v16, v102, v103
    v_lshlrev_b32 v102, 16, v16
    v_and_b32 v103, 0xffff0000, v16
    v_pk_add_f32 v[104:105], v[64:65], v[10:11]
    v_cvt_pk_bf16_f32 v16, v104, v105
    v_lshlrev_b32 v104, 16, v16
    v_and_b32 v105, 0xffff0000, v16
    v_pk_mul_f32 v[104:105], v[104:105], v[12:13]
    v_cvt_pk_bf16_f32 v16, v104, v105
    v_lshlrev_b32 v104, 16, v16
    v_and_b32 v105, 0xffff0000, v16
    v_pk_add_f32 v[106:107], v[66:67], v[10:11]
    v_cvt_pk_bf16_f32 v16, v106, v107
    v_lshlrev_b32 v106, 16, v16
    v_and_b32 v107, 0xffff0000, v16
    v_pk_mul_f32 v[106:107], v[106:107], v[12:13]
    v_cvt_pk_bf16_f32 v16, v106, v107
    v_lshlrev_b32 v106, 16, v16
    v_and_b32 v107, 0xffff0000, v16
    v_pk_add_f32 v[108:109], v[68:69], v[10:11]
    v_cvt_pk_bf16_f32 v16, v108, v109
    v_lshlrev_b32 v108, 16, v16
    v_and_b32 v109, 0xffff0000, v16
    v_pk_mul_f32 v[108:109], v[108:109], v[12:13]
    v_cvt_pk_bf16_f32 v16, v108, v109
    v_lshlrev_b32 v108, 16, v16
    v_and_b32 v109, 0xffff0000, v16
    v_lshrrev_b32 v7, 3, v0
    v_lshlrev_b32 v7, 2, v7
    v_lshl_add_u32 v7, v0, 4, v7
    s_waitcnt vmcnt(0)
    ds_write2_b32 v7, v40, v41 offset0:0 offset1:1
    ds_write2_b32 v7, v42, v43 offset0:2 offset1:3
    v_cmp_gt_u32 vcc, 128, v0
    s_and_saveexec_b64 s[30:31], vcc
    v_add_u32 v9, 8448, v7
    ds_write2_b32 v9, v44, v45 offset0:0 offset1:1
    ds_write2_b32 v9, v46, v47 offset0:2 offset1:3
    s_mov_b64 exec, s[30:31]
    v_mul_u32_u24 v7, 132, v1
    v_lshl_add_u32 v7, v2, 1, v7
    v_lshrrev_b32 v9, 2, v1
    v_lshlrev_b32 v9, 2, v9
    v_lshl_add_u32 v9, v1, 5, v9
    v_lshl_add_u32 v9, v2, 1, v9
    s_waitcnt lgkmcnt(0)
    s_barrier
    ds_read_u16_d16_hi v80, v7 offset:0
    ds_read_u16_d16_hi v81, v7 offset:16
    ds_read_u16_d16_hi v82, v7 offset:32
    ds_read_u16_d16_hi v83, v7 offset:48
    ds_read_u16_d16_hi v84, v7 offset:64
    ds_read_u16_d16_hi v85, v7 offset:80
    ds_read_u16_d16_hi v86, v7 offset:96
    ds_read_u16_d16_hi v87, v7 offset:112
    ds_read_u16_d16_hi v88, v9 offset:8448
    ds_read_u16_d16_hi v89, v9 offset:8464
    s_waitcnt lgkmcnt(0)
    v_and_b32 v80, 0xffff0000, v80
    v_and_b32 v81, 0xffff0000, v81
    v_and_b32 v82, 0xffff0000, v82
    v_and_b32 v83, 0xffff0000, v83
    v_and_b32 v84, 0xffff0000, v84
    v_and_b32 v85, 0xffff0000, v85
    v_and_b32 v86, 0xffff0000, v86
    v_and_b32 v87, 0xffff0000, v87
    v_and_b32 v88, 0xffff0000, v88
    v_and_b32 v89, 0xffff0000, v89
    v_cvt_pk_bf16_f32 v112, v80, v81
    v_cvt_pk_bf16_f32 v113, v82, v83
    v_cvt_pk_bf16_f32 v114, v84, v85
    v_cvt_pk_bf16_f32 v115, v86, v87
    v_cvt_pk_bf16_f32 v116, v88, v89
    buffer_store_dwordx4 v[112:115], v6, s[24:27], 0 offen
    buffer_store_dword v116, v8, s[24:27], 0 offen offset:1024
    v_pk_mul_f32 v[100:101], v[100:101], v[80:81]
    v_cvt_pk_bf16_f32 v16, v100, v101
    v_lshlrev_b32 v100, 16, v16
    v_and_b32 v101, 0xffff0000, v16
    v_pk_add_f32 v[60:61], v[60:61], v[100:101]
    v_cvt_pk_bf16_f32 v120, v60, v61
    v_lshlrev_b32 v60, 16, v120
    v_and_b32 v61, 0xffff0000, v120
    v_pk_mul_f32 v[102:103], v[102:103], v[82:83]
    v_cvt_pk_bf16_f32 v16, v102, v103
    v_lshlrev_b32 v102, 16, v16
    v_and_b32 v103, 0xffff0000, v16
    v_pk_add_f32 v[62:63], v[62:63], v[102:103]
    v_cvt_pk_bf16_f32 v121, v62, v63
    v_lshlrev_b32 v62, 16, v121
    v_and_b32 v63, 0xffff0000, v121
    v_pk_mul_f32 v[104:105], v[104:105], v[84:85]
    v_cvt_pk_bf16_f32 v16, v104, v105
    v_lshlrev_b32 v104, 16, v16
    v_and_b32 v105, 0xffff0000, v16
    v_pk_add_f32 v[64:65], v[64:65], v[104:105]
    v_cvt_pk_bf16_f32 v122, v64, v65
    v_lshlrev_b32 v64, 16, v122
    v_and_b32 v65, 0xffff0000, v122
    v_pk_mul_f32 v[106:107], v[106:107], v[86:87]
    v_cvt_pk_bf16_f32 v16, v106, v107
    v_lshlrev_b32 v106, 16, v16
    v_and_b32 v107, 0xffff0000, v16
    v_pk_add_f32 v[66:67], v[66:67], v[106:107]
    v_cvt_pk_bf16_f32 v123, v66, v67
    v_lshlrev_b32 v66, 16, v123
    v_and_b32 v67, 0xffff0000, v123
    v_pk_mul_f32 v[108:109], v[108:109], v[88:89]
    v_cvt_pk_bf16_f32 v16, v108, v109
    v_lshlrev_b32 v108, 16, v16
    v_and_b32 v109, 0xffff0000, v16
    v_pk_add_f32 v[68:69], v[68:69], v[108:109]
    v_cvt_pk_bf16_f32 v124, v68, v69
    v_lshlrev_b32 v68, 16, v124
    v_and_b32 v69, 0xffff0000, v124
    buffer_store_dwordx4 v[120:123], v6, s[16:19], 0 offen
    buffer_store_dword v124, v8, s[16:19], 0 offen offset:1024
    v_pk_add_f32 v[10:11], v[60:61], v[62:63]
    v_pk_add_f32 v[10:11], v[10:11], v[64:65]
    v_pk_add_f32 v[10:11], v[10:11], v[66:67]
    v_pk_add_f32 v[10:11], v[10:11], v[68:69]
    v_add_f32 v10, v10, v11
    s_nop 1
    v_add_f32_dpp v10, v10, v10 row_shr:1 row_mask:0xf bank_mask:0xf bound_ctrl:0
    s_nop 1
    v_add_f32_dpp v10, v10, v10 row_shr:2 row_mask:0xf bank_mask:0xf bound_ctrl:0
    s_nop 1
    v_add_f32_dpp v10, v10, v10 row_shr:4 row_mask:0xf bank_mask:0xf bound_ctrl:0
    s_nop 1
    v_add_f32_dpp v10, v10, v10 row_shr:8 row_mask:0xf bank_mask:0xf bound_ctrl:0
    s_nop 1
    v_add_f32_dpp v10, v10, v10 row_bcast:15 row_mask:0xa bank_mask:0xf
    s_nop 1
    v_add_f32_dpp v10, v10, v10 row_bcast:31 row_mask:0xc bank_mask:0xf
    s_nop 1
    v_readlane_b32 s40, v10, 63
    s_nop 1
    v_mov_b32 v10, s40
    v_mul_f32 v10, -0.0015625, v10
    v_mov_b32 v11, v10
    v_pk_add_f32 v[12:13], v[60:61], v[10:11]
    v_pk_mul_f32 v[14:15], v[12:13], v[12:13]
    v_pk_add_f32 v[12:13], v[62:63], v[10:11]
    v_pk_fma_f32 v[14:15], v[12:13], v[12:13], v[14:15]
    v_pk_add_f32 v[12:13], v[64:65], v[10:11]
    v_pk_fma_f32 v[14:15], v[12:13], v[12:13], v[14:15]
    v_pk_add_f32 v[12:13], v[66:67], v[10:11]
    v_pk_fma_f32 v[14:15], v[12:13], v[12:13], v[14:15]
    v_pk_add_f32 v[12:13], v[68:69], v[10:11]
    v_pk_fma_f32 v[14:15], v[12:13], v[12:13], v[14:15]
    v_add_f32 v12, v14, v15
    s_nop 1
    v_add_f32_dpp v12, v12, v12 row_shr:1 row_mask:0xf bank_mask:0xf bound_ctrl:0
    s_nop 1
    v_add_f32_dpp v12, v12, v12 row_shr:2 row_mask:0xf bank_mask:0xf bound_ctrl:0
    s_nop 1
    v_add_f32_dpp v12, v12, v12 row_shr:4 row_mask:0xf bank_mask:0xf bound_ctrl:0
    s_nop 1
    v_add_f32_dpp v12, v12, v12 row_shr:8 row_mask:0xf bank_mask:0xf bound_ctrl:0
    s_nop 1
    v_add_f32_dpp v12, v12, v12 row_bcast:15 row_mask:0xa bank_mask:0xf
    s_nop 1
    v_add_f32_dpp v12, v12, v12 row_bcast:31 row_mask:0xc bank_mask:0xf
    s_nop 1
    v_readlane_b32 s41, v12, 63
    s_nop 1
    v_mov_b32 v11, s41
    v_mul_f32 v11, 0.0015625, v11
    v_cvt_pk_bf16_f32 v12, v10, v11
    v_lshlrev_b32 v10, 16, v12
    v_and_b32 v11, 0xffff0000, v12
    v_add_f32 v11, 0x3727c5ac, v11
    v_cvt_pk_bf16_f32 v12, v11, v11
    v_lshlrev_b32 v11, 16, v12
    v_and_b32 v11, 0xffff0000, v12
    v_sqrt_f32 v11, v11
    s_nop 0
    v_cvt_pk_bf16_f32 v12, v11, v11
    v_lshlrev_b32 v11, 16, v12
    v_and_b32 v11, 0xffff0000, v12
    v_rcp_f32 v12, v11
    v_mov_b32 v11, v10
    v_mov_b32 v13, v12
    v_pk_add_f32 v[100:101], v[60:61], v[10:11]
    v_cvt_pk_bf16_f32 v16, v100, v101
    v_lshlrev_b32 v100, 16, v16
    v_and_b32 v101, 0xffff0000, v16
    v_pk_mul_f32 v[100:101], v[100:101], v[12:13]
    v_cvt_pk_bf16_f32 v16, v100, v101
    v_lshlrev_b32 v100, 16, v16
    v_and_b32 v101, 0xffff0000, v16
    v_pk_add_f32 v[102:103], v[62:63], v[10:11]
    v_cvt_pk_bf16_f32 v16, v102, v103
    v_lshlrev_b32 v102, 16, v16
    v_and_b32 v103, 0xffff0000, v16
    v_pk_mul_f32 v[102:103], v[102:103], v[12:13]
    v_cvt_pk_bf16_f32 v16, v102, v103
    v_lshlrev_b32 v102, 16, v16
    v_and_b32 v103, 0xffff0000, v16
    v_pk_add_f32 v[104:105], v[64:65], v[10:11]
    v_cvt_pk_bf16_f32 v16, v104, v105
    v_lshlrev_b32 v104, 16, v16
    v_and_b32 v105, 0xffff0000, v16
    v_pk_mul_f32 v[104:105], v[104:105], v[12:13]
    v_cvt_pk_bf16_f32 v16, v104, v105
    v_lshlrev_b32 v104, 16, v16
    v_and_b32 v105, 0xffff0000, v16
    v_pk_add_f32 v[106:107], v[66:67], v[10:11]
    v_cvt_pk_bf16_f32 v16, v106, v107
    v_lshlrev_b32 v106, 16, v16
    v_and_b32 v107, 0xffff0000, v16
    v_pk_mul_f32 v[106:107], v[106:107], v[12:13]
    v_cvt_pk_bf16_f32 v16, v106, v107
    v_lshlrev_b32 v106, 16, v16
    v_and_b32 v107, 0xffff0000, v16
    v_pk_add_f32 v[108:109], v[68:69], v[10:11]
    v_cvt_pk_bf16_f32 v16, v108, v109
    v_lshlrev_b32 v108, 16, v16
    v_and_b32 v109, 0xffff0000, v16
    v_pk_mul_f32 v[108:109], v[108:109], v[12:13]
    v_cvt_pk_bf16_f32 v16, v108, v109
    v_lshlrev_b32 v108, 16, v16
    v_and_b32 v109, 0xffff0000, v16
    v_cvt_pk_bf16_f32 v128, v100, v101
    v_cvt_pk_bf16_f32 v129, v102, v103
    v_cvt_pk_bf16_f32 v130, v104, v105
    v_cvt_pk_bf16_f32 v131, v106, v107
    v_cvt_pk_bf16_f32 v132, v108, v109
    v_lshlrev_b32 v7, 15, v1
    v_lshl_add_u32 v7, v5, 4, v7
    buffer_store_dwordx4 v[128:131], v7, s[20:23], 0 offen
    v_lshrrev_b32 v7, 2, v1
    v_lshlrev_b32 v7, 15, v7
    v_lshl_add_u32 v7, v5, 4, v7
    v_and_b32 v9, 3, v1
    v_lshl_add_u32 v7, v9, 2, v7
    v_add_u32 v7, 0x200000, v7
    buffer_store_dword v132, v7, s[20:23], 0 offen
L_lnx0_kernel_end:
    s_endpgm
.globl gemm1_0_kernel
.p2align 8
.type gemm1_0_kernel,@function
gemm1_0_kernel:
    s_cmp_ge_u32 s2, 256
    s_cbranch_scc1 L_gemm1_0_kernel_end
    s_load_dwordx2 s[4:5], s[0:1], 104
    s_load_dwordx4 s[28:31], s[0:1], 64
    s_load_dwordx2 s[32:33], s[0:1], 88
    s_and_b32 s6, s2, 7
    s_lshr_b32 s7, s2, 3
    s_mul_i32 s22, s6, 2
    s_lshr_b32 s3, s7, 4
    s_add_u32 s22, s22, s3
    s_and_b32 s23, s7, 15
    v_and_b32 v1, 63, v0
    v_and_b32 v2, 15, v0
    v_bfe_u32 v3, v0, 4, 2
    v_lshrrev_b32 v4, 6, v0
    s_nop 0
    v_readfirstlane_b32 s21, v4
    s_mul_i32 s34, s22, 128
    s_mul_i32 s35, s23, 96
    s_cmp_lt_u32 s21, 4
    s_cbranch_scc1 L_gemm1_0_kernel_comp
    s_sub_u32 s21, s21, 4
    s_setprio 3
    s_mul_i32 s3, s21, 256
    s_add_u32 s3, s3, 0
    v_add_u32 v5, s3, v1
    v_lshrrev_b32 v6, 7, v5
    v_and_b32 v5, 127, v5
    v_mul_u32_u24 v6, 2048, v6
    v_add3_u32 v5, v5, v6, s34
    v_lshlrev_b32 v10, 4, v5
    s_mul_i32 s3, s21, 256
    s_add_u32 s3, s3, 64
    v_add_u32 v5, s3, v1
    v_lshrrev_b32 v6, 7, v5
    v_and_b32 v5, 127, v5
    v_mul_u32_u24 v6, 2048, v6
    v_add3_u32 v5, v5, v6, s34
    v_lshlrev_b32 v11, 4, v5
    s_mul_i32 s3, s21, 256
    s_add_u32 s3, s3, 128
    v_add_u32 v5, s3, v1
    v_lshrrev_b32 v6, 7, v5
    v_and_b32 v5, 127, v5
    v_mul_u32_u24 v6, 2048, v6
    v_add3_u32 v5, v5, v6, s34
    v_lshlrev_b32 v12, 4, v5
    s_mul_i32 s3, s21, 256
    s_add_u32 s3, s3, 192
    v_add_u32 v5, s3, v1
    v_lshrrev_b32 v6, 7, v5
    v_and_b32 v5, 127, v5
    v_mul_u32_u24 v6, 2048, v6
    v_add3_u32 v5, v5, v6, s34
    v_lshlrev_b32 v13, 4, v5
    s_lshl_b32 s3, s21, 6
    s_add_u32 s3, s3, 0
    v_add_u32 v5, s3, v1
    v_mul_u32_u24 v6, 683, v5
    v_lshrrev_b32 v6, 16, v6
    v_mul_u32_u24 v7, 96, v6
    v_sub_u32 v7, v5, v7
    v_mul_u32_u24 v6, 1536, v6
    v_add3_u32 v7, v7, v6, s35
    v_lshlrev_b32 v14, 4, v7
    s_lshl_b32 s3, s21, 6
    s_add_u32 s3, s3, 256
    v_add_u32 v5, s3, v1
    v_mul_u32_u24 v6, 683, v5
    v_lshrrev_b32 v6, 16, v6
    v_mul_u32_u24 v7, 96, v6
    v_sub_u32 v7, v5, v7
    v_mul_u32_u24 v6, 1536, v6
    v_add3_u32 v7, v7, v6, s35
    v_lshlrev_b32 v15, 4, v7
    s_lshl_b32 s3, s21, 6
    s_add_u32 s3, s3, 512
    v_add_u32 v5, s3, v1
    v_mul_u32_u24 v6, 683, v5
    v_lshrrev_b32 v6, 16, v6
    v_mul_u32_u24 v7, 96, v6
    v_sub_u32 v7, v5, v7
    v_mul_u32_u24 v6, 1536, v6
    v_add3_u32 v7, v7, v6, s35
    v_lshlrev_b32 v16, 4, v7
    s_mul_i32 s24, s21, 4096
    s_lshl_b32 s25, s21, 10
    s_add_u32 s25, s25, 16384
    s_mov_b32 s16, 0
    s_mov_b32 s17, 0
    s_mov_b32 s18, 0
    s_waitcnt lgkmcnt(0)
    s_add_u32 s8, s4, 20971520
    s_addc_u32 s9, s5, 0
    s_mov_b32 s10, 2621440
    s_mov_b32 s11, 0x00020000
    s_add_u32 s12, s4, 8388608
    s_addc_u32 s13, s5, 0
    s_mov_b32 s14, 1966080
    s_mov_b32 s15, 0x00020000
    s_add_u32 s26, s18, s24
    s_add_u32 s27, s18, s25
    s_add_u32 m0, s26, 0
    s_nop 0
    buffer_load_dwordx4 v10, s[8:11], s16 offen lds
    s_add_u32 m0, s26, 1024
    s_nop 0
    buffer_load_dwordx4 v11, s[8:11], s16 offen lds
    s_add_u32 m0, s26, 2048
    s_nop 0
    buffer_load_dwordx4 v12, s[8:11], s16 offen lds
    s_add_u32 m0, s26, 3072
    s_nop 0
    buffer_load_dwordx4 v13, s[8:11], s16 offen lds
    s_add_u32 m0, s27, 0
    s_nop 0
    buffer_load_dwordx4 v14, s[12:15], s17 offen lds
    s_add_u32 m0, s27, 4096
    s_nop 0
    buffer_load_dwordx4 v15, s[12:15], s17 offen lds
    s_add_u32 m0, s27, 8192
    s_nop 0
    buffer_load_dwordx4 v16, s[12:15], s17 offen lds
    s_add_u32 s16, s16, 262144
    s_add_u32 s17, s17, 196608
    s_add_u32 s18, s18, 28672
    s_cmp_eq_u32 s18, 143360
    s_cselect_b32 s18, 0, s18
    s_add_u32 s26, s18, s24
    s_add_u32 s27, s18, s25
    s_add_u32 m0, s26, 0
    s_nop 0
    buffer_load_dwordx4 v10, s[8:11], s16 offen lds
    s_add_u32 m0, s26, 1024
    s_nop 0
    buffer_load_dwordx4 v11, s[8:11], s16 offen lds
    s_add_u32 m0, s26, 2048
    s_nop 0
    buffer_load_dwordx4 v12, s[8:11], s16 offen lds
    s_add_u32 m0, s26, 3072
    s_nop 0
    buffer_load_dwordx4 v13, s[8:11], s16 offen lds
    s_add_u32 m0, s27, 0
    s_nop 0
    buffer_load_dwordx4 v14, s[12:15], s17 offen lds
    s_add_u32 m0, s27, 4096
    s_nop 0
    buffer_load_dwordx4 v15, s[12:15], s17 offen lds
    s_add_u32 m0, s27, 8192
    s_nop 0
    buffer_load_dwordx4 v16, s[12:15], s17 offen lds
    s_add_u32 s16, s16, 262144
    s_add_u32 s17, s17, 196608
    s_add_u32 s18, s18, 28672
    s_cmp_eq_u32 s18, 143360
    s_cselect_b32 s18, 0, s18
    s_add_u32 s26, s18, s24
    s_add_u32 s27, s18, s25
    s_add_u32 m0, s26, 0
    s_nop 0
    buffer_load_dwordx4 v10, s[8:11], s16 offen lds
    s_add_u32 m0, s26, 1024
    s_nop 0
    buffer_load_dwordx4 v11, s[8:11], s16 offen lds
    s_add_u32 m0, s26, 2048
    s_nop 0
    buffer_load_dwordx4 v12, s[8:11], s16 offen lds
    s_add_u32 m0, s26, 3072
    s_nop 0
    buffer_load_dwordx4 v13, s[8:11], s16 offen lds
    s_add_u32 m0, s27, 0
    s_nop 0
    buffer_load_dwordx4 v14, s[12:15], s17 offen lds
    s_add_u32 m0, s27, 4096
    s_nop 0
    buffer_load_dwordx4 v15, s[12:15], s17 offen lds
    s_add_u32 m0, s27, 8192
    s_nop 0
    buffer_load_dwordx4 v16, s[12:15], s17 offen lds
    s_add_u32 s16, s16, 262144
    s_add_u32 s17, s17, 196608
    s_add_u32 s18, s18, 28672
    s_cmp_eq_u32 s18, 143360
    s_cselect_b32 s18, 0, s18
    s_add_u32 s26, s18, s24
    s_add_u32 s27, s18, s25
    s_add_u32 m0, s26, 0
    s_nop 0
    buffer_load_dwordx4 v10, s[8:11], s16 offen lds
    s_add_u32 m0, s26, 1024
    s_nop 0
    buffer_load_dwordx4 v11, s[8:11], s16 offen lds
    s_add_u32 m0, s26, 2048
    s_nop 0
    buffer_load_dwordx4 v12, s[8:11], s16 offen lds
    s_add_u32 m0, s26, 3072
    s_nop 0
    buffer_load_dwordx4 v13, s[8:11], s16 offen lds
    s_add_u32 m0, s27, 0
    s_nop 0
    buffer_load_dwordx4 v14, s[12:15], s17 offen lds
    s_add_u32 m0, s27, 4096
    s_nop 0
    buffer_load_dwordx4 v15, s[12:15], s17 offen lds
    s_add_u32 m0, s27, 8192
    s_nop 0
    buffer_load_dwordx4 v16, s[12:15], s17 offen lds
    s_add_u32 s16, s16, 262144
    s_add_u32 s17, s17, 196608
    s_add_u32 s18, s18, 28672
    s_cmp_eq_u32 s18, 143360
    s_cselect_b32 s18, 0, s18
    s_waitcnt vmcnt(14)
    s_barrier
    s_add_u32 s26, s18, s24
    s_add_u32 s27, s18, s25
    s_add_u32 m0, s26, 0
    s_nop 0
    buffer_load_dwordx4 v10, s[8:11], s16 offen lds
    s_add_u32 m0, s26, 1024
    s_nop 0
    buffer_load_dwordx4 v11, s[8:11], s16 offen lds
    s_add_u32 m0, s26, 2048
    s_nop 0
    buffer_load_dwordx4 v12, s[8:11], s16 offen lds
    s_add_u32 m0, s26, 3072
    s_nop 0
    buffer_load_dwordx4 v13, s[8:11], s16 offen lds
    s_add_u32 m0, s27, 0
    s_nop 0
    buffer_load_dwordx4 v14, s[12:15], s17 offen lds
    s_add_u32 m0, s27, 4096
    s_nop 0
    buffer_load_dwordx4 v15, s[12:15], s17 offen lds
    s_add_u32 m0, s27, 8192
    s_nop 0
    buffer_load_dwordx4 v16, s[12:15], s17 offen lds
    s_add_u32 s16, s16, 262144
    s_add_u32 s17, s17, 196608
    s_add_u32 s18, s18, 28672
    s_cmp_eq_u32 s18, 143360
    s_cselect_b32 s18, 0, s18
    s_waitcnt vmcnt(14)
    s_barrier
    s_add_u32 s26, s18, s24
    s_add_u32 s27, s18, s25
    s_add_u32 m0, s26, 0
    s_nop 0
    buffer_load_dwordx4 v10, s[8:11], s16 offen lds
    s_add_u32 m0, s26, 1024
    s_nop 0
    buffer_load_dwordx4 v11, s[8:11], s16 offen lds
    s_add_u32 m0, s26, 2048
    s_nop 0
    buffer_load_dwordx4 v12, s[8:11], s16 offen lds
    s_add_u32 m0, s26, 3072
    s_nop 0
    buffer_load_dwordx4 v13, s[8:11], s16 offen lds
    s_add_u32 m0, s27, 0
    s_nop 0
    buffer_load_dwordx4 v14, s[12:15], s17 offen lds
    s_add_u32 m0, s27, 4096
    s_nop 0
    buffer_load_dwordx4 v15, s[12:15], s17 offen lds
    s_add_u32 m0, s27, 8192
    s_nop 0
    buffer_load_dwordx4 v16, s[12:15], s17 offen lds
    s_add_u32 s16, s16, 262144
    s_add_u32 s17, s17, 196608
    s_add_u32 s18, s18, 28672
    s_cmp_eq_u32 s18, 143360
    s_cselect_b32 s18, 0, s18
    s_add_u32 s26, s18, s24
    s_add_u32 s27, s18, s25
    s_add_u32 m0, s26, 0
    s_nop 0
    buffer_load_dwordx4 v10, s[8:11], s16 offen lds
    s_add_u32 m0, s26, 1024
    s_nop 0
    buffer_load_dwordx4 v11, s[8:11], s16 offen lds
    s_add_u32 m0, s26, 2048
    s_nop 0
    buffer_load_dwordx4 v12, s[8:11], s16 offen lds
    s_add_u32 m0, s26, 3072
    s_nop 0
    buffer_load_dwordx4 v13, s[8:11], s16 offen lds
    s_add_u32 m0, s27, 0
    s_nop 0
    buffer_load_dwordx4 v14, s[12:15], s17 offen lds
    s_add_u32 m0, s27, 4096
    s_nop 0
    buffer_load_dwordx4 v15, s[12:15], s17 offen lds
    s_add_u32 m0, s27, 8192
    s_nop 0
    buffer_load_dwordx4 v16, s[12:15], s17 offen lds
    s_add_u32 s16, s16, 262144
    s_add_u32 s17, s17, 196608
    s_add_u32 s18, s18, 28672
    s_cmp_eq_u32 s18, 143360
    s_cselect_b32 s18, 0, s18
    s_mov_b32 s20, 3
L_gemm1_0_kernel_lloop:
    s_waitcnt vmcnt(21)
    s_barrier
    s_add_u32 s26, s18, s24
    s_add_u32 s27, s18, s25
    s_add_u32 m0, s26, 0
    s_nop 0
    buffer_load_dwordx4 v10, s[8:11], s16 offen lds
    s_add_u32 m0, s26, 1024
    s_nop 0
    buffer_load_dwordx4 v11, s[8:11], s16 offen lds
    s_add_u32 m0, s26, 2048
    s_nop 0
    buffer_load_dwordx4 v12, s[8:11], s16 offen lds
    s_add_u32 m0, s26, 3072
    s_nop 0
    buffer_load_dwordx4 v13, s[8:11], s16 offen lds
    s_add_u32 m0, s27, 0
    s_nop 0
    buffer_load_dwordx4 v14, s[12:15], s17 offen lds
    s_add_u32 m0, s27, 4096
    s_nop 0
    buffer_load_dwordx4 v15, s[12:15], s17 offen lds
    s_add_u32 m0, s27, 8192
    s_nop 0
    buffer_load_dwordx4 v16, s[12:15], s17 offen lds
    s_add_u32 s16, s16, 262144
    s_add_u32 s17, s17, 196608
    s_add_u32 s18, s18, 28672
    s_cmp_eq_u32 s18, 143360
    s_cselect_b32 s18, 0, s18
    s_sub_u32 s20, s20, 1
    s_cmp_lg_u32 s20, 0
    s_cbranch_scc1 L_gemm1_0_kernel_lloop
    s_waitcnt vmcnt(21)
    s_barrier
    s_waitcnt vmcnt(14)
    s_barrier
    s_waitcnt vmcnt(7)
    s_barrier
    s_waitcnt vmcnt(0)
    s_barrier
    s_waitcnt vmcnt(0)
    s_barrier
    s_waitcnt vmcnt(0)
    s_barrier
    s_cmp_ge_u32 s2, 8
    s_cbranch_scc1 L_cpf_3
    v_lshlrev_b32 v5, 4, v0
    s_getpc_b64 s[100:101]
L_cpfpc_3_0:
    s_add_u32 s100, s100, lnz0_kernel-L_cpfpc_3_0
    s_addc_u32 s101, s101, (lnz0_kernel-L_cpfpc_3_0)>>32
    v_cmp_gt_u32 vcc, L_text_end-lnz0_kernel-16, v5
    s_and_saveexec_b64 s[98:99], vcc
    global_load_dwordx4 v[24:27], v5, s[100:101]
    s_mov_b64 exec, s[98:99]
L_cpf_3:
    s_branch L_gemm1_0_kernel_ldepi
L_gemm1_0_kernel_comp:
    s_lshr_b32 s36, s21, 1
    s_and_b32 s37, s21, 1
    s_mul_i32 s36, s36, 64
    s_mul_i32 s37, s37, 48
    v_mul_u32_u24 v5, 128, v3
    v_add3_u32 v5, v5, v2, s36
    v_lshlrev_b32 v18, 4, v5
    v_mul_u32_u24 v5, 96, v3
    v_add3_u32 v5, v5, v2, s37
    v_lshlrev_b32 v5, 4, v5
    v_add_u32 v20, 16384, v5
    v_mov_b32 v136, 0
    v_mov_b32 v137, 0
    v_mov_b32 v138, 0
    v_mov_b32 v139, 0
    v_mov_b32 v140, 0
    v_mov_b32 v141, 0
    v_mov_b32 v142, 0
    v_mov_b32 v143, 0
    v_mov_b32 v144, 0
    v_mov_b32 v145, 0
    v_mov_b32 v146, 0
    v_mov_b32 v147, 0
    v_mov_b32 v148, 0
    v_mov_b32 v149, 0
    v_mov_b32 v150, 0
    v_mov_b32 v151, 0
    v_mov_b32 v152, 0
    v_mov_b32 v153, 0
    v_mov_b32 v154, 0
    v_mov_b32 v155, 0
    v_mov_b32 v156, 0
    v_mov_b32 v157, 0
    v_mov_b32 v158, 0
    v_mov_b32 v159, 0
    v_mov_b32 v160, 0
    v_mov_b32 v161, 0
    v_mov_b32 v162, 0
    v_mov_b32 v163, 0
    v_mov_b32 v164, 0
    v_mov_b32 v165, 0
    v_mov_b32 v166, 0
    v_mov_b32 v167, 0
    v_mov_b32 v168, 0
    v_mov_b32 v169, 0
    v_mov_b32 v170, 0
    v_mov_b32 v171, 0
    v_mov_b32 v172, 0
    v_mov_b32 v173, 0
    v_mov_b32 v174, 0
    v_mov_b32 v175, 0
    v_mov_b32 v176, 0
    v_mov_b32 v177, 0
    v_mov_b32 v178, 0
    v_mov_b32 v179, 0
    v_mov_b32 v180, 0
    v_mov_b32 v181, 0
    v_mov_b32 v182, 0
    v_mov_b32 v183, 0
    s_waitcnt lgkmcnt(0)
    s_mov_b32 s19, 0
    s_mov_b32 s20, 5
    v_add_u32 v21, s19, v18
    v_add_u32 v23, s19, v20
    s_mov_b32 s82, 0
    s_barrier
    ds_read_b128 v[24:27], v21 offset:0
    ds_read_b128 v[28:31], v21 offset:256
    ds_read_b128 v[32:35], v21 offset:512
    ds_read_b128 v[36:39], v21 offset:768
    ds_read_b128 v[40:43], v23 offset:0
    ds_read_b128 v[44:47], v23 offset:256
    ds_read_b128 v[48:51], v23 offset:512
    ds_read_b128 v[52:55], v21 offset:8192
    ds_read_b128 v[56:59], v21 offset:8448
    ds_read_b128 v[60:63], v21 offset:8704
    ds_read_b128 v[64:67], v21 offset:8960
    ds_read_b128 v[68:71], v23 offset:6144
    ds_read_b128 v[72:75], v23 offset:6400
    ds_read_b128 v[76:79], v23 offset:6656
    s_add_u32 s19, s19, 28672
    s_cmp_eq_u32 s19, 143360
    s_cselect_b32 s19, 0, s19
    v_add_u32 v21, s19, v18
    v_add_u32 v23, s19, v20
    s_waitcnt lgkmcnt(0)
L_gemm1_0_kernel_loop:
    v_mfma_f32_16x16x32_bf16 v[136:139], v[40:43], v[24:27], v[136:139]
    ds_read_b128 v[80:83], v21 offset:0
    v_mfma_f32_16x16x32_bf16 v[140:143], v[44:47], v[24:27], v[140:143]
    ds_read_b128 v[84:87], v21 offset:256
    v_mfma_f32_16x16x32_bf16 v[144:147], v[48:51], v[24:27], v[144:147]
    ds_read_b128 v[88:91], v21 offset:512
    v_mfma_f32_16x16x32_bf16 v[148:151], v[40:43], v[28:31], v[148:151]
    ds_read_b128 v[92:95], v21 offset:768
    v_mfma_f32_16x16x32_bf16 v[152:155], v[44:47], v[28:31], v[152:155]
    ds_read_b128 v[96:99], v23 offset:0
    v_mfma_f32_16x16x32_bf16 v[156:159], v[48:51], v[28:31], v[156:159]
    ds_read_b128 v[100:103], v23 offset:256
    v_mfma_f32_16x16x32_bf16 v[160:163], v[40:43], v[32:35], v[160:163]
    ds_read_b128 v[104:107], v23 offset:512
    v_mfma_f32_16x16x32_bf16 v[164:167], v[44:47], v[32:35], v[164:167]
    ds_read_b128 v[108:111], v21 offset:8192
    v_mfma_f32_16x16x32_bf16 v[168:171], v[48:51], v[32:35], v[168:171]
    ds_read_b128 v[112:115], v21 offset:8448
    v_mfma_f32_16x16x32_bf16 v[172:175], v[40:43], v[36:39], v[172:175]
    ds_read_b128 v[116:119], v21 offset:8704
    v_mfma_f32_16x16x32_bf16 v[176:179], v[44:47], v[36:39], v[176:179]
    ds_read_b128 v[120:123], v21 offset:8960
    v_mfma_f32_16x16x32_bf16 v[180:183], v[48:51], v[36:39], v[180:183]
    ds_read_b128 v[124:127], v23 offset:6144
    v_mfma_f32_16x16x32_bf16 v[136:139], v[68:71], v[52:55], v[136:139]
    ds_read_b128 v[128:131], v23 offset:6400
    v_mfma_f32_16x16x32_bf16 v[140:143], v[72:75], v[52:55], v[140:143]
    ds_read_b128 v[132:135], v23 offset:6656
    v_mfma_f32_16x16x32_bf16 v[144:147], v[76:79], v[52:55], v[144:147]
    v_mfma_f32_16x16x32_bf16 v[148:151], v[68:71], v[56:59], v[148:151]
    v_mfma_f32_16x16x32_bf16 v[152:155], v[72:75], v[56:59], v[152:155]
    v_mfma_f32_16x16x32_bf16 v[156:159], v[76:79], v[56:59], v[156:159]
    v_mfma_f32_16x16x32_bf16 v[160:163], v[68:71], v[60:63], v[160:163]
    v_mfma_f32_16x16x32_bf16 v[164:167], v[72:75], v[60:63], v[164:167]
    v_mfma_f32_16x16x32_bf16 v[168:171], v[76:79], v[60:63], v[168:171]
    v_mfma_f32_16x16x32_bf16 v[172:175], v[68:71], v[64:67], v[172:175]
    v_mfma_f32_16x16x32_bf16 v[176:179], v[72:75], v[64:67], v[176:179]
    v_mfma_f32_16x16x32_bf16 v[180:183], v[76:79], v[64:67], v[180:183]
    s_add_u32 s19, s19, 28672
    s_cmp_eq_u32 s19, 143360
    s_cselect_b32 s19, 0, s19
    v_add_u32 v21, s19, v18
    v_add_u32 v23, s19, v20
    s_waitcnt lgkmcnt(0)
    s_barrier
    v_mfma_f32_16x16x32_bf16 v[136:139], v[96:99], v[80:83], v[136:139]
    ds_read_b128 v[24:27], v21 offset:0
    v_mfma_f32_16x16x32_bf16 v[140:143], v[100:103], v[80:83], v[140:143]
    ds_read_b128 v[28:31], v21 offset:256
    v_mfma_f32_16x16x32_bf16 v[144:147], v[104:107], v[80:83], v[144:147]
    ds_read_b128 v[32:35], v21 offset:512
    v_mfma_f32_16x16x32_bf16 v[148:151], v[96:99], v[84:87], v[148:151]
    ds_read_b128 v[36:39], v21 offset:768
    v_mfma_f32_16x16x32_bf16 v[152:155], v[100:103], v[84:87], v[152:155]
    ds_read_b128 v[40:43], v23 offset:0
    v_mfma_f32_16x16x32_bf16 v[156:159], v[104:107], v[84:87], v[156:159]
    ds_read_b128 v[44:47], v23 offset:256
    v_mfma_f32_16x16x32_bf16 v[160:163], v[96:99], v[88:91], v[160:163]
    ds_read_b128 v[48:51], v23 offset:512
    v_mfma_f32_16x16x32_bf16 v[164:167], v[100:103], v[88:91], v[164:167]
    ds_read_b128 v[52:55], v21 offset:8192
    v_mfma_f32_16x16x32_bf16 v[168:171], v[104:107], v[88:91], v[168:171]
    ds_read_b128 v[56:59], v21 offset:8448
    v_mfma_f32_16x16x32_bf16 v[172:175], v[96:99], v[92:95], v[172:175]
    ds_read_b128 v[60:63], v21 offset:8704
    v_mfma_f32_16x16x32_bf16 v[176:179], v[100:103], v[92:95], v[176:179]
    ds_read_b128 v[64:67], v21 offset:8960
    v_mfma_f32_16x16x32_bf16 v[180:183], v[104:107], v[92:95], v[180:183]
    ds_read_b128 v[68:71], v23 offset:6144
    v_mfma_f32_16x16x32_bf16 v[136:139], v[124:127], v[108:111], v[136:139]
    ds_read_b128 v[72:75], v23 offset:6400
    v_mfma_f32_16x16x32_bf16 v[140:143], v[128:131], v[108:111], v[140:143]
    ds_read_b128 v[76:79], v23 offset:6656
    v_mfma_f32_16x16x32_bf16 v[144:147], v[132:135], v[108:111], v[144:147]
    v_mfma_f32_16x16x32_bf16 v[148:151], v[124:127], v[112:115], v[148:151]
    v_mfma_f32_16x16x32_bf16 v[152:155], v[128:131], v[112:115], v[152:155]
    v_mfma_f32_16x16x32_bf16 v[156:159], v[132:135], v[112:115], v[156:159]
    v_mfma_f32_16x16x32_bf16 v[160:163], v[124:127], v[116:119], v[160:163]
    v_mfma_f32_16x16x32_bf16 v[164:167], v[128:131], v[116:119], v[164:167]
    v_mfma_f32_16x16x32_bf16 v[168:171], v[132:135], v[116:119], v[168:171]
    v_mfma_f32_16x16x32_bf16 v[172:175], v[124:127], v[120:123], v[172:175]
    v_mfma_f32_16x16x32_bf16 v[176:179], v[128:131], v[120:123], v[176:179]
    v_mfma_f32_16x16x32_bf16 v[180:183], v[132:135], v[120:123], v[180:183]
    s_add_u32 s19, s19, 28672
    s_cmp_eq_u32 s19, 143360
    s_cselect_b32 s19, 0, s19
    v_add_u32 v21, s19, v18
    v_add_u32 v23, s19, v20
    s_waitcnt lgkmcnt(0)
    s_barrier
    s_sub_u32 s20, s20, 1
    s_cmp_lg_u32 s20, 0
    s_cbranch_scc1 L_gemm1_0_kernel_loop
    s_nop 7
    s_nop 1
    s_waitcnt vmcnt(0) lgkmcnt(0)
    v_lshlrev_b32 v5, 4, v1
    s_mul_i32 s3, s21, 6144
    v_add_u32 v5, s3, v5
    ds_write_b128 v5, v[160:163] offset:0
    ds_write_b128 v5, v[164:167] offset:1024
    ds_write_b128 v5, v[168:171] offset:2048
    ds_write_b128 v5, v[172:175] offset:3072
    ds_write_b128 v5, v[176:179] offset:4096
    ds_write_b128 v5, v[180:183] offset:5120
    s_waitcnt lgkmcnt(0)
    s_barrier
    s_branch L_gemm1_0_kernel_epi
L_gemm1_0_kernel_ldepi:
    s_lshr_b32 s36, s21, 1
    s_and_b32 s37, s21, 1
    s_mul_i32 s36, s36, 64
    s_add_u32 s36, s36, 32
    s_mul_i32 s37, s37, 48
    v_lshlrev_b32 v5, 4, v1
    s_mul_i32 s3, s21, 6144
    v_add_u32 v5, s3, v5
    s_barrier
    ds_read_b128 v[136:139], v5 offset:0
    ds_read_b128 v[140:143], v5 offset:1024
    ds_read_b128 v[144:147], v5 offset:2048
    ds_read_b128 v[148:151], v5 offset:3072
    ds_read_b128 v[152:155], v5 offset:4096
    ds_read_b128 v[156:159], v5 offset:5120
    s_waitcnt lgkmcnt(0)
L_gemm1_0_kernel_epi:
    s_cmp_lt_u32 s23, 8
    s_mov_b32 s3, 29360128
    s_cselect_b32 s3, 25165824, s3
    s_add_u32 s40, s4, s3
    s_addc_u32 s41, s5, 0
    s_mov_b32 s42, 3145728
    s_mov_b32 s43, 0x00020000
    s_and_b32 s3, s23, 7
    s_mul_i32 s3, s3, 96
    s_add_u32 s3, s3, s37
    s_add_u32 s6, s34, s36
    v_add_u32 v5, s6, v2
    v_mul_u32_u24 v5, 1536, v5
    v_lshl_add_u32 v6, v3, 2, s3
    v_lshl_add_u32 v5, v6, 1, v5
    v_mov_b32 v190, 0xc0135761
    v_mov_b32 v191, 0xc0135761
    v_mov_b32 v192, 0xbdd2d3e8
    v_mov_b32 v193, 0xbdd2d3e8
    v_mov_b32 v194, 0x3f800000
    v_mov_b32 v195, 0x3f800000
    v_cvt_pk_bf16_f32 v188, v136, v137
    v_lshlrev_b32 v136, 16, v188
    v_and_b32 v137, 0xffff0000, v188
    v_cvt_pk_bf16_f32 v189, v138, v139
    v_lshlrev_b32 v138, 16, v189
    v_and_b32 v139, 0xffff0000, v189
    v_pk_mul_f32 v[184:185], v[136:137], v[136:137]
    v_pk_mul_f32 v[186:187], v[138:139], v[138:139]
    v_pk_fma_f32 v[184:185], v[184:185], v[192:193], v[190:191]
    v_pk_fma_f32 v[186:187], v[186:187], v[192:193], v[190:191]
    v_pk_mul_f32 v[184:185], v[184:185], v[136:137]
    v_pk_mul_f32 v[186:187], v[186:187], v[138:139]
    v_exp_f32 v184, v184
    v_exp_f32 v185, v185
    v_exp_f32 v186, v186
    v_exp_f32 v187, v187
    s_nop 0
    v_pk_add_f32 v[184:185], v[184:185], v[194:195]
    v_pk_add_f32 v[186:187], v[186:187], v[194:195]
    v_rcp_f32 v184, v184
    v_rcp_f32 v185, v185
    v_rcp_f32 v186, v186
    v_rcp_f32 v187, v187
    s_nop 0
    v_pk_mul_f32 v[184:185], v[184:185], v[136:137]
    v_pk_mul_f32 v[186:187], v[186:187], v[138:139]
    v_cvt_pk_bf16_f32 v136, v184, v185
    v_cvt_pk_bf16_f32 v137, v186, v187
    buffer_store_dwordx2 v[136:137], v5, s[40:43], 0 offen offset:0
    v_cvt_pk_bf16_f32 v188, v140, v141
    v_lshlrev_b32 v140, 16, v188
    v_and_b32 v141, 0xffff0000, v188
    v_cvt_pk_bf16_f32 v189, v142, v143
    v_lshlrev_b32 v142, 16, v189
    v_and_b32 v143, 0xffff0000, v189
    v_pk_mul_f32 v[184:185], v[140:141], v[140:141]
    v_pk_mul_f32 v[186:187], v[142:143], v[142:143]
    v_pk_fma_f32 v[184:185], v[184:185], v[192:193], v[190:191]
    v_pk_fma_f32 v[186:187], v[186:187], v[192:193], v[190:191]
    v_pk_mul_f32 v[184:185], v[184:185], v[140:141]
    v_pk_mul_f32 v[186:187], v[186:187], v[142:143]
    v_exp_f32 v184, v184
    v_exp_f32 v185, v185
    v_exp_f32 v186, v186
    v_exp_f32 v187, v187
    s_nop 0
    v_pk_add_f32 v[184:185], v[184:185], v[194:195]
    v_pk_add_f32 v[186:187], v[186:187], v[194:195]
    v_rcp_f32 v184, v184
    v_rcp_f32 v185, v185
    v_rcp_f32 v186, v186
    v_rcp_f32 v187, v187
    s_nop 0
    v_pk_mul_f32 v[184:185], v[184:185], v[140:141]
    v_pk_mul_f32 v[186:187], v[186:187], v[142:143]
    v_cvt_pk_bf16_f32 v140, v184, v185
    v_cvt_pk_bf16_f32 v141, v186, v187
    buffer_store_dwordx2 v[140:141], v5, s[40:43], 0 offen offset:32
    v_cvt_pk_bf16_f32 v188, v144, v145
    v_lshlrev_b32 v144, 16, v188
    v_and_b32 v145, 0xffff0000, v188
    v_cvt_pk_bf16_f32 v189, v146, v147
    v_lshlrev_b32 v146, 16, v189
    v_and_b32 v147, 0xffff0000, v189
    v_pk_mul_f32 v[184:185], v[144:145], v[144:145]
    v_pk_mul_f32 v[186:187], v[146:147], v[146:147]
    v_pk_fma_f32 v[184:185], v[184:185], v[192:193], v[190:191]
    v_pk_fma_f32 v[186:187], v[186:187], v[192:193], v[190:191]
    v_pk_mul_f32 v[184:185], v[184:185], v[144:145]
    v_pk_mul_f32 v[186:187], v[186:187], v[146:147]
    v_exp_f32 v184, v184
    v_exp_f32 v185, v185
    v_exp_f32 v186, v186
    v_exp_f32 v187, v187
    s_nop 0
    v_pk_add_f32 v[184:185], v[184:185], v[194:195]
    v_pk_add_f32 v[186:187], v[186:187], v[194:195]
    v_rcp_f32 v184, v184
    v_rcp_f32 v185, v185
    v_rcp_f32 v186, v186
    v_rcp_f32 v187, v187
    s_nop 0
    v_pk_mul_f32 v[184:185], v[184:185], v[144:145]
    v_pk_mul_f32 v[186:187], v[186:187], v[146:147]
    v_cvt_pk_bf16_f32 v144, v184, v185
    v_cvt_pk_bf16_f32 v145, v186, v187
    buffer_store_dwordx2 v[144:145], v5, s[40:43], 0 offen offset:64
    v_cvt_pk_bf16_f32 v188, v148, v149
    v_lshlrev_b32 v148, 16, v188
    v_and_b32 v149, 0xffff0000, v188
    v_cvt_pk_bf16_f32 v189, v150, v151
    v_lshlrev_b32 v150, 16, v189
    v_and_b32 v151, 0xffff0000, v189
    v_pk_mul_f32 v[184:185], v[148:149], v[148:149]
    v_pk_mul_f32 v[186:187], v[150:151], v[150:151]
    v_pk_fma_f32 v[184:185], v[184:185], v[192:193], v[190:191]
    v_pk_fma_f32 v[186:187], v[186:187], v[192:193], v[190:191]
    v_pk_mul_f32 v[184:185], v[184:185], v[148:149]
    v_pk_mul_f32 v[186:187], v[186:187], v[150:151]
    v_exp_f32 v184, v184
    v_exp_f32 v185, v185
    v_exp_f32 v186, v186
    v_exp_f32 v187, v187
    s_nop 0
    v_pk_add_f32 v[184:185], v[184:185], v[194:195]
    v_pk_add_f32 v[186:187], v[186:187], v[194:195]
    v_rcp_f32 v184, v184
    v_rcp_f32 v185, v185
    v_rcp_f32 v186, v186
    v_rcp_f32 v187, v187
    s_nop 0
    v_pk_mul_f32 v[184:185], v[184:185], v[148:149]
    v_pk_mul_f32 v[186:187], v[186:187], v[150:151]
    v_cvt_pk_bf16_f32 v148, v184, v185
    v_cvt_pk_bf16_f32 v149, v186, v187
    v_add_u32 v5, 24576, v5
    buffer_store_dwordx2 v[148:149], v5, s[40:43], 0 offen offset:0
    v_cvt_pk_bf16_f32 v188, v152, v153
    v_lshlrev_b32 v152, 16, v188
    v_and_b32 v153, 0xffff0000, v188
    v_cvt_pk_bf16_f32 v189, v154, v155
    v_lshlrev_b32 v154, 16, v189
    v_and_b32 v155, 0xffff0000, v189
    v_pk_mul_f32 v[184:185], v[152:153], v[152:153]
    v_pk_mul_f32 v[186:187], v[154:155], v[154:155]
    v_pk_fma_f32 v[184:185], v[184:185], v[192:193], v[190:191]
    v_pk_fma_f32 v[186:187], v[186:187], v[192:193], v[190:191]
    v_pk_mul_f32 v[184:185], v[184:185], v[152:153]
    v_pk_mul_f32 v[186:187], v[186:187], v[154:155]
    v_exp_f32 v184, v184
    v_exp_f32 v185, v185
    v_exp_f32 v186, v186
    v_exp_f32 v187, v187
    s_nop 0
    v_pk_add_f32 v[184:185], v[184:185], v[194:195]
    v_pk_add_f32 v[186:187], v[186:187], v[194:195]
    v_rcp_f32 v184, v184
    v_rcp_f32 v185, v185
    v_rcp_f32 v186, v186
    v_rcp_f32 v187, v187
    s_nop 0
    v_pk_mul_f32 v[184:185], v[184:185], v[152:153]
    v_pk_mul_f32 v[186:187], v[186:187], v[154:155]
    v_cvt_pk_bf16_f32 v152, v184, v185
    v_cvt_pk_bf16_f32 v153, v186, v187
    buffer_store_dwordx2 v[152:153], v5, s[40:43], 0 offen offset:32
    v_cvt_pk_bf16_f32 v188, v156, v157
    v_lshlrev_b32 v156, 16, v188
    v_and_b32 v157, 0xffff0000, v188
    v_cvt_pk_bf16_f32 v189, v158, v159
    v_lshlrev_b32 v158, 16, v189
    v_and_b32 v159, 0xffff0000, v189
    v_pk_mul_f32 v[184:185], v[156:157], v[156:157]
    v_pk_mul_f32 v[186:187], v[158:159], v[158:159]
    v_pk_fma_f32 v[184:185], v[184:185], v[192:193], v[190:191]
    v_pk_fma_f32 v[186:187], v[186:187], v[192:193], v[190:191]
    v_pk_mul_f32 v[184:185], v[184:185], v[156:157]
    v_pk_mul_f32 v[186:187], v[186:187], v[158:159]
    v_exp_f32 v184, v184
    v_exp_f32 v185, v185
    v_exp_f32 v186, v186
    v_exp_f32 v187, v187
    s_nop 0
    v_pk_add_f32 v[184:185], v[184:185], v[194:195]
    v_pk_add_f32 v[186:187], v[186:187], v[194:195]
    v_rcp_f32 v184, v184
    v_rcp_f32 v185, v185
    v_rcp_f32 v186, v186
    v_rcp_f32 v187, v187
    s_nop 0
    v_pk_mul_f32 v[184:185], v[184:185], v[156:157]
    v_pk_mul_f32 v[186:187], v[186:187], v[158:159]
    v_cvt_pk_bf16_f32 v156, v184, v185
    v_cvt_pk_bf16_f32 v157, v186, v187
    buffer_store_dwordx2 v[156:157], v5, s[40:43], 0 offen offset:64
L_gemm1_0_kernel_end:
    s_endpgm
.globl lnz0_kernel
.p2align 8
.type lnz0_kernel,@function
lnz0_kernel:
    s_cmp_ge_u32 s2, 256
    s_cbranch_scc1 L_lnz0_kernel_end
    s_cmp_ge_u32 s2, 8
    s_cbranch_scc1 L_cpf_4
    v_lshlrev_b32 v1, 4, v0
    s_getpc_b64 s[100:101]
L_cpfpc_4_0:
    s_add_u32 s100, s100, gemm2_0_kernel-L_cpfpc_4_0
    s_addc_u32 s101, s101, (gemm2_0_kernel-L_cpfpc_4_0)>>32
    v_cmp_gt_u32 vcc, L_text_end-gemm2_0_kernel-16, v1
    s_and_saveexec_b64 s[98:99], vcc
    global_load_dwordx4 v[92:95], v1, s[100:101]
    s_mov_b64 exec, s[98:99]
L_cpf_4:
    s_load_dwordx2 s[4:5], s[0:1], 104
    s_and_b32 s3, s2, 7
    s_lshl_b32 s3, s3, 5
    s_lshr_b32 s2, s2, 3
    s_add_u32 s2, s2, s3
    v_and_b32 v1, 63, v0
    v_lshrrev_b32 v2, 6, v0
    s_lshl_b32 s3, s2, 3
    v_add_u32 v5, s3, v2
    v_mul_u32_u24 v8, 1536, v5
    v_lshl_add_u32 v6, v1, 4, v8
    v_lshl_add_u32 v8, v1, 3, v8
    s_waitcnt lgkmcnt(0)
    s_add_u32 s8, s4, 29360128
    s_addc_u32 s9, s5, 0
    s_mov_b32 s10, 3145728
    s_mov_b32 s11, 0x00020000
    buffer_load_dwordx4 v[48:51], v6, s[8:11], 0 offen
    buffer_load_dwordx2 v[52:53], v8, s[8:11], 0 offen offset:1024
    s_add_u32 s12, s4, 33554432
    s_addc_u32 s13, s5, 0
    s_mov_b32 s14, 3145728
    s_mov_b32 s15, 0x00020000
    v_mul_u32_u24 v7, 132, v1
    v_lshl_add_u32 v7, v2, 1, v7
    v_lshrrev_b32 v9, 1, v1
    v_lshlrev_b32 v9, 2, v9
    v_lshl_add_u32 v9, v1, 6, v9
    v_lshl_add_u32 v9, v2, 1, v9
    s_waitcnt vmcnt(0)
    v_lshlrev_b32 v60, 16, v48
    v_and_b32 v61, 0xffff0000, v48
    v_lshlrev_b32 v62, 16, v49
    v_and_b32 v63, 0xffff0000, v49
    v_lshlrev_b32 v64, 16, v50
    v_and_b32 v65, 0xffff0000, v50
    v_lshlrev_b32 v66, 16, v51
    v_and_b32 v67, 0xffff0000, v51
    v_lshlrev_b32 v68, 16, v52
    v_and_b32 v69, 0xffff0000, v52
    v_lshlrev_b32 v70, 16, v53
    v_and_b32 v71, 0xffff0000, v53
    v_pk_add_f32 v[10:11], v[60:61], v[62:63]
    v_pk_add_f32 v[10:11], v[10:11], v[64:65]
    v_pk_add_f32 v[10:11], v[10:11], v[66:67]
    v_pk_add_f32 v[10:11], v[10:11], v[68:69]
    v_pk_add_f32 v[10:11], v[10:11], v[70:71]
    v_add_f32 v10, v10, v11
    s_nop 1
    v_add_f32_dpp v10, v10, v10 row_shr:1 row_mask:0xf bank_mask:0xf bound_ctrl:0
    s_nop 1
    v_add_f32_dpp v10, v10, v10 row_shr:2 row_mask:0xf bank_mask:0xf bound_ctrl:0
    s_nop 1
    v_add_f32_dpp v10, v10, v10 row_shr:4 row_mask:0xf bank_mask:0xf bound_ctrl:0
    s_nop 1
    v_add_f32_dpp v10, v10, v10 row_shr:8 row_mask:0xf bank_mask:0xf bound_ctrl:0
    s_nop 1
    v_add_f32_dpp v10, v10, v10 row_bcast:15 row_mask:0xa bank_mask:0xf
    s_nop 1
    v_add_f32_dpp v10, v10, v10 row_bcast:31 row_mask:0xc bank_mask:0xf
    s_nop 1
    v_readlane_b32 s40, v10, 63
    s_nop 1
    v_mov_b32 v10, s40
    v_mul_f32 v10, -0.0013020833333333333, v10
    v_mov_b32 v11, v10
    v_pk_add_f32 v[12:13], v[60:61], v[10:11]
    v_pk_mul_f32 v[14:15], v[12:13], v[12:13]
    v_pk_add_f32 v[12:13], v[62:63], v[10:11]
    v_pk_fma_f32 v[14:15], v[12:13], v[12:13], v[14:15]
    v_pk_add_f32 v[12:13], v[64:65], v[10:11]
    v_pk_fma_f32 v[14:15], v[12:13], v[12:13], v[14:15]
    v_pk_add_f32 v[12:13], v[66:67], v[10:11]
    v_pk_fma_f32 v[14:15], v[12:13], v[12:13], v[14:15]
    v_pk_add_f32 v[12:13], v[68:69], v[10:11]
    v_pk_fma_f32 v[14:15], v[12:13], v[12:13], v[14:15]
    v_pk_add_f32 v[12:13], v[70:71], v[10:11]
    v_pk_fma_f32 v[14:15], v[12:13], v[12:13], v[14:15]
    v_add_f32 v12, v14, v15
    s_nop 1
    v_add_f32_dpp v12, v12, v12 row_shr:1 row_mask:0xf bank_mask:0xf bound_ctrl:0
    s_nop 1
    v_add_f32_dpp v12, v12, v12 row_shr:2 row_mask:0xf bank_mask:0xf bound_ctrl:0
    s_nop 1
    v_add_f32_dpp v12, v12, v12 row_shr:4 row_mask:0xf bank_mask:0xf bound_ctrl:0
    s_nop 1
    v_add_f32_dpp v12, v12, v12 row_shr:8 row_mask:0xf bank_mask:0xf bound_ctrl:0
    s_nop 1
    v_add_f32_dpp v12, v12, v12 row_bcast:15 row_mask:0xa bank_mask:0xf
    s_nop 1
    v_add_f32_dpp v12, v12, v12 row_bcast:31 row_mask:0xc bank_mask:0xf
    s_nop 1
    v_readlane_b32 s41, v12, 63
    s_nop 1
    v_mov_b32 v11, s41
    v_mul_f32 v11, 0.0013020833333333333, v11
    v_cvt_pk_bf16_f32 v12, v10, v11
    v_lshlrev_b32 v10, 16, v12
    v_and_b32 v11, 0xffff0000, v12
    v_add_f32 v11, 0x3727c5ac, v11
    v_cvt_pk_bf16_f32 v12, v11, v11
    v_lshlrev_b32 v11, 16, v12
    v_and_b32 v11, 0xffff0000, v12
    v_sqrt_f32 v11, v11
    s_nop 0
    v_cvt_pk_bf16_f32 v12, v11, v11
    v_lshlrev_b32 v11, 16, v12
    v_and_b32 v11, 0xffff0000, v12
    v_rcp_f32 v12, v11
    v_mov_b32 v11, v10
    v_mov_b32 v13, v12
    v_pk_add_f32 v[100:101], v[60:61], v[10:11]
    v_cvt_pk_bf16_f32 v16, v100, v101
    v_lshlrev_b32 v100, 16, v16
    v_and_b32 v101, 0xffff0000, v16
    v_pk_mul_f32 v[100:101], v[100:101], v[12:13]
    v_cvt_pk_bf16_f32 v16, v100, v101
    v_lshlrev_b32 v100, 16, v16
    v_and_b32 v101, 0xffff0000, v16
    v_pk_add_f32 v[102:103], v[62:63], v[10:11]
    v_cvt_pk_bf16_f32 v16, v102, v103
    v_lshlrev_b32 v102, 16, v16
    v_and_b32 v103, 0xffff0000, v16
    v_pk_mul_f32 v[102:103], v[102:103], v[12:13]
    v_cvt_pk_bf16_f32 v16, v102, v103
    v_lshlrev_b32 v102, 16, v16
    v_and_b32 v103, 0xffff0000, v16
    v_pk_add_f32 v[104:105], v[64:65], v[10:11]
    v_cvt_pk_bf16_f32 v16, v104, v105
    v_lshlrev_b32 v104, 16, v16
    v_and_b32 v105, 0xffff0000, v16
    v_pk_mul_f32 v[104:105], v[104:105], v[12:13]
    v_cvt_pk_bf16_f32 v16, v104, v105
    v_lshlrev_b32 v104, 16, v16
    v_and_b32 v105, 0xffff0000, v16
    v_pk_add_f32 v[106:107], v[66:67], v[10:11]
    v_cvt_pk_bf16_f32 v16, v106, v107
    v_lshlrev_b32 v106, 16, v16
    v_and_b32 v107, 0xffff0000, v16
    v_pk_mul_f32 v[106:107], v[106:107], v[12:13]
    v_cvt_pk_bf16_f32 v16, v106, v107
    v_lshlrev_b32 v106, 16, v16
    v_and_b32 v107, 0xffff0000, v16
    v_pk_add_f32 v[108:109], v[68:69], v[10:11]
    v_cvt_pk_bf16_f32 v16, v108, v109
    v_lshlrev_b32 v108, 16, v16
    v_and_b32 v109, 0xffff0000, v16
    v_pk_mul_f32 v[108:109], v[108:109], v[12:13]
    v_cvt_pk_bf16_f32 v16, v108, v109
    v_lshlrev_b32 v108, 16, v16
    v_and_b32 v109, 0xffff0000, v16
    v_pk_add_f32 v[110:111], v[70:71], v[10:11]
    v_cvt_pk_bf16_f32 v16, v110, v111
    v_lshlrev_b32 v110, 16, v16
    v_and_b32 v111, 0xffff0000, v16
    v_pk_mul_f32 v[110:111], v[110:111], v[12:13]
    v_cvt_pk_bf16_f32 v16, v110, v111
    v_lshlrev_b32 v110, 16, v16
    v_and_b32 v111, 0xffff0000, v16
    ds_write_b16_d16_hi v7, v100 offset:0
    ds_write_b16_d16_hi v7, v101 offset:16
    ds_write_b16_d16_hi v7, v102 offset:32
    ds_write_b16_d16_hi v7, v103 offset:48
    ds_write_b16_d16_hi v7, v104 offset:64
    ds_write_b16_d16_hi v7, v105 offset:80
    ds_write_b16_d16_hi v7, v106 offset:96
    ds_write_b16_d16_hi v7, v107 offset:112
    ds_write_b16_d16_hi v9, v108 offset:8448
    ds_write_b16_d16_hi v9, v109 offset:8464
    ds_write_b16_d16_hi v9, v110 offset:8480
    ds_write_b16_d16_hi v9, v111 offset:8496
    v_lshrrev_b32 v7, 3, v0
    v_lshlrev_b32 v7, 2, v7
    v_lshl_add_u32 v7, v0, 4, v7
    s_mul_i32 s24, s2, 12288
    v_lshlrev_b32 v8, 4, v0
    s_waitcnt lgkmcnt(0)
    s_barrier
    ds_read2_b32 v[20:21], v7 offset0:0 offset1:1
    ds_read2_b32 v[22:23], v7 offset0:2 offset1:3
    v_cmp_gt_u32 vcc, 256, v0
    s_and_saveexec_b64 s[30:31], vcc
    v_add_u32 v7, 8448, v7
    ds_read2_b32 v[24:25], v7 offset0:0 offset1:1
    ds_read2_b32 v[26:27], v7 offset0:2 offset1:3
    s_waitcnt lgkmcnt(0)
    v_add_u32 v10, 8192, v8
    buffer_store_dwordx4 v[24:27], v10, s[12:15], s24 offen
    s_mov_b64 exec, s[30:31]
    s_waitcnt lgkmcnt(0)
    buffer_store_dwordx4 v[20:23], v8, s[12:15], s24 offen
L_lnz0_kernel_end:
    s_endpgm
.globl gemm2_0_kernel
.p2align 8
.type gemm2_0_kernel,@function
gemm2_0_kernel:
    s_cmp_ge_u32 s2, 256
    s_cbranch_scc1 L_gemm2_0_kernel_end
    s_load_dwordx2 s[4:5], s[0:1], 104
    s_load_dwordx4 s[28:31], s[0:1], 64
    s_load_dwordx2 s[32:33], s[0:1], 88
    s_and_b32 s6, s2, 7
    s_lshr_b32 s7, s2, 3
    s_mul_i32 s22, s6, 4
    s_lshr_b32 s3, s7, 3
    s_add_u32 s22, s22, s3
    s_and_b32 s23, s7, 7
    v_and_b32 v1, 63, v0
    v_and_b32 v2, 15, v0
    v_bfe_u32 v3, v0, 4, 2
    v_lshrrev_b32 v4, 6, v0
    s_nop 0
    v_readfirstlane_b32 s21, v4
    s_mul_i32 s34, s22, 64
    s_mul_i32 s35, s23, 96
    s_cmp_lt_u32 s21, 4
    s_cbranch_scc1 L_gemm2_0_kernel_comp
    s_sub_u32 s21, s21, 4
    s_setprio 3
    s_mul_i32 s3, s21, 128
    s_add_u32 s3, s3, 0
    v_add_u32 v5, s3, v1
    v_lshrrev_b32 v6, 3, v5
    v_and_b32 v5, 7, v5
    v_bfe_u32 v7, v6, 1, 3
    v_xor_b32 v5, v5, v7
    v_add_u32 v6, s34, v6
    v_mul_u32_u24 v6, 4096, v6
    v_lshl_add_u32 v10, v5, 4, v6
    s_mul_i32 s3, s21, 128
    s_add_u32 s3, s3, 64
    v_add_u32 v5, s3, v1
    v_lshrrev_b32 v6, 3, v5
    v_and_b32 v5, 7, v5
    v_bfe_u32 v7, v6, 1, 3
    v_xor_b32 v5, v5, v7
    v_add_u32 v6, s34, v6
    v_mul_u32_u24 v6, 4096, v6
    v_lshl_add_u32 v11, v5, 4, v6
    s_lshl_b32 s3, s21, 6
    s_add_u32 s3, s3, 0
    v_add_u32 v5, s3, v1
    v_mul_u32_u24 v6, 683, v5
    v_lshrrev_b32 v6, 16, v6
    v_mul_u32_u24 v7, 96, v6
    v_sub_u32 v7, v5, v7
    v_mul_u32_u24 v6, 768, v6
    v_add3_u32 v7, v7, v6, s35
    v_lshlrev_b32 v14, 4, v7
    s_lshl_b32 s3, s21, 6
    s_add_u32 s3, s3, 256
    v_add_u32 v5, s3, v1
    v_mul_u32_u24 v6, 683, v5
    v_lshrrev_b32 v6, 16, v6
    v_mul_u32_u24 v7, 96, v6
    v_sub_u32 v7, v5, v7
    v_mul_u32_u24 v6, 768, v6
    v_add3_u32 v7, v7, v6, s35
    v_lshlrev_b32 v15, 4, v7
    s_lshl_b32 s3, s21, 6
    s_add_u32 s3, s3, 512
    v_add_u32 v5, s3, v1
    v_mul_u32_u24 v6, 683, v5
    v_lshrrev_b32 v6, 16, v6
    v_mul_u32_u24 v7, 96, v6
    v_sub_u32 v7, v5, v7
    v_mul_u32_u24 v6, 768, v6
    v_add3_u32 v7, v7, v6, s35
    v_lshlrev_b32 v16, 4, v7
    s_mul_i32 s24, s21, 2048
    s_lshl_b32 s25, s21, 10
    s_add_u32 s25, s25, 8192
    s_mov_b32 s16, 0
    s_mov_b32 s17, 0
    s_mov_b32 s18, 0
    s_waitcnt lgkmcnt(0)
    s_mov_b32 s8, s28
    s_mov_b32 s9, s29
    s_mov_b32 s10, 8388608
    s_mov_b32 s11, 0x00020000
    s_add_u32 s12, s4, 33554432
    s_addc_u32 s13, s5, 0
    s_mov_b32 s14, 3145728
    s_mov_b32 s15, 0x00020000
    s_add_u32 s26, s18, s24
    s_add_u32 s27, s18, s25
    s_add_u32 m0, s26, 0
    s_nop 0
    buffer_load_dwordx4 v10, s[8:11], s16 offen lds
    s_add_u32 m0, s26, 1024
    s_nop 0
    buffer_load_dwordx4 v11, s[8:11], s16 offen lds
    s_add_u32 m0, s27, 0
    s_nop 0
    buffer_load_dwordx4 v14, s[12:15], s17 offen lds
    s_add_u32 m0, s27, 4096
    s_nop 0
    buffer_load_dwordx4 v15, s[12:15], s17 offen lds
    s_add_u32 m0, s27, 8192
    s_nop 0
    buffer_load_dwordx4 v16, s[12:15], s17 offen lds
    s_add_u32 s16, s16, 128
    s_add_u32 s17, s17, 98304
    s_add_u32 s18, s18, 20480
    s_cmp_eq_u32 s18, 143360
    s_cselect_b32 s18, 0, s18
    s_add_u32 s26, s18, s24
    s_add_u32 s27, s18, s25
    s_add_u32 m0, s26, 0
    s_nop 0
    buffer_load_dwordx4 v10, s[8:11], s16 offen lds
    s_add_u32 m0, s26, 1024
    s_nop 0
    buffer_load_dwordx4 v11, s[8:11], s16 offen lds
    s_add_u32 m0, s27, 0
    s_nop 0
    buffer_load_dwordx4 v14, s[12:15], s17 offen lds
    s_add_u32 m0, s27, 4096
    s_nop 0
    buffer_load_dwordx4 v15, s[12:15], s17 offen lds
    s_add_u32 m0, s27, 8192
    s_nop 0
    buffer_load_dwordx4 v16, s[12:15], s17 offen lds
    s_add_u32 s16, s16, 128
    s_add_u32 s17, s17, 98304
    s_add_u32 s18, s18, 20480
    s_cmp_eq_u32 s18, 143360
    s_cselect_b32 s18, 0, s18
    s_add_u32 s26, s18, s24
    s_add_u32 s27, s18, s25
    s_add_u32 m0, s26, 0
    s_nop 0
    buffer_load_dwordx4 v10, s[8:11], s16 offen lds
    s_add_u32 m0, s26, 1024
    s_nop 0
    buffer_load_dwordx4 v11, s[8:11], s16 offen lds
    s_add_u32 m0, s27, 0
    s_nop 0
    buffer_load_dwordx4 v14, s[12:15], s17 offen lds
    s_add_u32 m0, s27, 4096
    s_nop 0
    buffer_load_dwordx4 v15, s[12:15], s17 offen lds
    s_add_u32 m0, s27, 8192
    s_nop 0
    buffer_load_dwordx4 v16, s[12:15], s17 offen lds
    s_add_u32 s16, s16, 128
    s_add_u32 s17, s17, 98304
    s_add_u32 s18, s18, 20480
    s_cmp_eq_u32 s18, 143360
    s_cselect_b32 s18, 0, s18
    s_add_u32 s26, s18, s24
    s_add_u32 s27, s18, s25
    s_add_u32 m0, s26, 0
    s_nop 0
    buffer_load_dwordx4 v10, s[8:11], s16 offen lds
    s_add_u32 m0, s26, 1024
    s_nop 0
    buffer_load_dwordx4 v11, s[8:11], s16 offen lds
    s_add_u32 m0, s27, 0
    s_nop 0
    buffer_load_dwordx4 v14, s[12:15], s17 offen lds
    s_add_u32 m0, s27, 4096
    s_nop 0
    buffer_load_dwordx4 v15, s[12:15], s17 offen lds
    s_add_u32 m0, s27, 8192
    s_nop 0
    buffer_load_dwordx4 v16, s[12:15], s17 offen lds
    s_add_u32 s16, s16, 128
    s_add_u32 s17, s17, 98304
    s_add_u32 s18, s18, 20480
    s_cmp_eq_u32 s18, 143360
    s_cselect_b32 s18, 0, s18
    s_waitcnt vmcnt(10)
    s_barrier
    s_add_u32 s26, s18, s24
    s_add_u32 s27, s18, s25
    s_add_u32 m0, s26, 0
    s_nop 0
    buffer_load_dwordx4 v10, s[8:11], s16 offen lds
    s_add_u32 m0, s26, 1024
    s_nop 0
    buffer_load_dwordx4 v11, s[8:11], s16 offen lds
    s_add_u32 m0, s27, 0
    s_nop 0
    buffer_load_dwordx4 v14, s[12:15], s17 offen lds
    s_add_u32 m0, s27, 4096
    s_nop 0
    buffer_load_dwordx4 v15, s[12:15], s17 offen lds
    s_add_u32 m0, s27, 8192
    s_nop 0
    buffer_load_dwordx4 v16, s[12:15], s17 offen lds
    s_add_u32 s16, s16, 128
    s_add_u32 s17, s17, 98304
    s_add_u32 s18, s18, 20480
    s_cmp_eq_u32 s18, 143360
    s_cselect_b32 s18, 0, s18
    s_add_u32 s26, s18, s24
    s_add_u32 s27, s18, s25
    s_add_u32 m0, s26, 0
    s_nop 0
    buffer_load_dwordx4 v10, s[8:11], s16 offen lds
    s_add_u32 m0, s26, 1024
    s_nop 0
    buffer_load_dwordx4 v11, s[8:11], s16 offen lds
    s_add_u32 m0, s27, 0
    s_nop 0
    buffer_load_dwordx4 v14, s[12:15], s17 offen lds
    s_add_u32 m0, s27, 4096
    s_nop 0
    buffer_load_dwordx4 v15, s[12:15], s17 offen lds
    s_add_u32 m0, s27, 8192
    s_nop 0
    buffer_load_dwordx4 v16, s[12:15], s17 offen lds
    s_add_u32 s16, s16, 128
    s_add_u32 s17, s17, 98304
    s_add_u32 s18, s18, 20480
    s_cmp_eq_u32 s18, 143360
    s_cselect_b32 s18, 0, s18
    s_waitcnt vmcnt(15)
    s_barrier
    s_add_u32 s26, s18, s24
    s_add_u32 s27, s18, s25
    s_add_u32 m0, s26, 0
    s_nop 0
    buffer_load_dwordx4 v10, s[8:11], s16 offen lds
    s_add_u32 m0, s26, 1024
    s_nop 0
    buffer_load_dwordx4 v11, s[8:11], s16 offen lds
    s_add_u32 m0, s27, 0
    s_nop 0
    buffer_load_dwordx4 v14, s[12:15], s17 offen lds
    s_add_u32 m0, s27, 4096
    s_nop 0
    buffer_load_dwordx4 v15, s[12:15], s17 offen lds
    s_add_u32 m0, s27, 8192
    s_nop 0
    buffer_load_dwordx4 v16, s[12:15], s17 offen lds
    s_add_u32 s16, s16, 128
    s_add_u32 s17, s17, 98304
    s_add_u32 s18, s18, 20480
    s_cmp_eq_u32 s18, 143360
    s_cselect_b32 s18, 0, s18
    s_add_u32 s26, s18, s24
    s_add_u32 s27, s18, s25
    s_add_u32 m0, s26, 0
    s_nop 0
    buffer_load_dwordx4 v10, s[8:11], s16 offen lds
    s_add_u32 m0, s26, 1024
    s_nop 0
    buffer_load_dwordx4 v11, s[8:11], s16 offen lds
    s_add_u32 m0, s27, 0
    s_nop 0
    buffer_load_dwordx4 v14, s[12:15], s17 offen lds
    s_add_u32 m0, s27, 4096
    s_nop 0
    buffer_load_dwordx4 v15, s[12:15], s17 offen lds
    s_add_u32 m0, s27, 8192
    s_nop 0
    buffer_load_dwordx4 v16, s[12:15], s17 offen lds
    s_add_u32 s16, s16, 128
    s_add_u32 s17, s17, 98304
    s_add_u32 s18, s18, 20480
    s_cmp_eq_u32 s18, 143360
    s_cselect_b32 s18, 0, s18
    s_waitcnt vmcnt(20)
    s_barrier
    s_add_u32 s26, s18, s24
    s_add_u32 s27, s18, s25
    s_add_u32 m0, s26, 0
    s_nop 0
    buffer_load_dwordx4 v10, s[8:11], s16 offen lds
    s_add_u32 m0, s26, 1024
    s_nop 0
    buffer_load_dwordx4 v11, s[8:11], s16 offen lds
    s_add_u32 m0, s27, 0
    s_nop 0
    buffer_load_dwordx4 v14, s[12:15], s17 offen lds
    s_add_u32 m0, s27, 4096
    s_nop 0
    buffer_load_dwordx4 v15, s[12:15], s17 offen lds
    s_add_u32 m0, s27, 8192
    s_nop 0
    buffer_load_dwordx4 v16, s[12:15], s17 offen lds
    s_add_u32 s16, s16, 128
    s_add_u32 s17, s17, 98304
    s_add_u32 s18, s18, 20480
    s_cmp_eq_u32 s18, 143360
    s_cselect_b32 s18, 0, s18
    s_add_u32 s26, s18, s24
    s_add_u32 s27, s18, s25
    s_add_u32 m0, s26, 0
    s_nop 0
    buffer_load_dwordx4 v10, s[8:11], s16 offen lds
    s_add_u32 m0, s26, 1024
    s_nop 0
    buffer_load_dwordx4 v11, s[8:11], s16 offen lds
    s_add_u32 m0, s27, 0
    s_nop 0
    buffer_load_dwordx4 v14, s[12:15], s17 offen lds
    s_add_u32 m0, s27, 4096
    s_nop 0
    buffer_load_dwordx4 v15, s[12:15], s17 offen lds
    s_add_u32 m0, s27, 8192
    s_nop 0
    buffer_load_dwordx4 v16, s[12:15], s17 offen lds
    s_add_u32 s16, s16, 128
    s_add_u32 s17, s17, 98304
    s_add_u32 s18, s18, 20480
    s_cmp_eq_u32 s18, 143360
    s_cselect_b32 s18, 0, s18
    s_mov_b32 s20, 22
L_gemm2_0_kernel_lloop:
    s_waitcnt vmcnt(25)
    s_barrier
    s_add_u32 s26, s18, s24
    s_add_u32 s27, s18, s25
    s_add_u32 m0, s26, 0
    s_nop 0
    buffer_load_dwordx4 v10, s[8:11], s16 offen lds
    s_add_u32 m0, s26, 1024
    s_nop 0
    buffer_load_dwordx4 v11, s[8:11], s16 offen lds
    s_add_u32 m0, s27, 0
    s_nop 0
    buffer_load_dwordx4 v14, s[12:15], s17 offen lds
    s_add_u32 m0, s27, 4096
    s_nop 0
    buffer_load_dwordx4 v15, s[12:15], s17 offen lds
    s_add_u32 m0, s27, 8192
    s_nop 0
    buffer_load_dwordx4 v16, s[12:15], s17 offen lds
    s_add_u32 s16, s16, 128
    s_add_u32 s17, s17, 98304
    s_add_u32 s18, s18, 20480
    s_cmp_eq_u32 s18, 143360
    s_cselect_b32 s18, 0, s18
    s_sub_u32 s20, s20, 1
    s_cmp_lg_u32 s20, 0
    s_cbranch_scc1 L_gemm2_0_kernel_lloop
    s_waitcnt vmcnt(25)
    s_barrier
    s_waitcnt vmcnt(20)
    s_barrier
    s_waitcnt vmcnt(15)
    s_barrier
    s_waitcnt vmcnt(10)
    s_barrier
    s_waitcnt vmcnt(5)
    s_barrier
    s_waitcnt vmcnt(0)
    s_barrier
    s_waitcnt vmcnt(0)
    s_barrier
    s_waitcnt vmcnt(0)
    s_barrier
    s_cmp_ge_u32 s2, 8
    s_cbranch_scc1 L_cpf_5
    v_lshlrev_b32 v5, 4, v0
    s_getpc_b64 s[100:101]
L_cpfpc_5_0:
    s_add_u32 s100, s100, gemm3_0_kernel-L_cpfpc_5_0
    s_addc_u32 s101, s101, (gemm3_0_kernel-L_cpfpc_5_0)>>32
    v_cmp_gt_u32 vcc, L_text_end-gemm3_0_kernel-16, v5
    s_and_saveexec_b64 s[98:99], vcc
    global_load_dwordx4 v[24:27], v5, s[100:101]
    s_mov_b64 exec, s[98:99]
    s_getpc_b64 s[100:101]
L_cpfpc_5_1:
    s_add_u32 s100, s100, gemm3_1_kernel-L_cpfpc_5_1
    s_addc_u32 s101, s101, (gemm3_1_kernel-L_cpfpc_5_1)>>32
    v_cmp_gt_u32 vcc, L_text_end-gemm3_1_kernel-16, v5
    s_and_saveexec_b64 s[98:99], vcc
    global_load_dwordx4 v[24:27], v5, s[100:101]
    s_mov_b64 exec, s[98:99]
L_cpf_5:
    s_branch L_gemm2_0_kernel_end
L_gemm2_0_kernel_comp:
    s_lshr_b32 s36, s21, 1
    s_and_b32 s37, s21, 1
    s_mul_i32 s36, s36, 32
    s_mul_i32 s37, s37, 48
    v_lshrrev_b32 v5, 1, v2
    v_xor_b32 v5, v5, v3
    v_add_u32 v6, s36, v2
    v_lshlrev_b32 v6, 7, v6
    v_lshl_add_u32 v18, v5, 4, v6
    v_xor_b32 v19, 64, v18
    v_mul_u32_u24 v5, 96, v3
    v_add3_u32 v5, v5, v2, s37
    v_lshlrev_b32 v5, 4, v5
    v_add_u32 v20, 8192, v5
    v_mov_b32 v104, 0
    v_mov_b32 v105, 0
    v_mov_b32 v106, 0
    v_mov_b32 v107, 0
    v_mov_b32 v108, 0
    v_mov_b32 v109, 0
    v_mov_b32 v110, 0
    v_mov_b32 v111, 0
    v_mov_b32 v112, 0
    v_mov_b32 v113, 0
    v_mov_b32 v114, 0
    v_mov_b32 v115, 0
    v_mov_b32 v116, 0
    v_mov_b32 v117, 0
    v_mov_b32 v118, 0
    v_mov_b32 v119, 0
    v_mov_b32 v120, 0
    v_mov_b32 v121, 0
    v_mov_b32 v122, 0
    v_mov_b32 v123, 0
    v_mov_b32 v124, 0
    v_mov_b32 v125, 0
    v_mov_b32 v126, 0
    v_mov_b32 v127, 0
    s_waitcnt lgkmcnt(0)
    s_add_u32 s40, s4, 25165824
    s_addc_u32 s41, s5, 0
    s_mov_b32 s42, 3145728
    s_mov_b32 s43, 0x00020000
    s_mov_b32 s44, s30
    s_mov_b32 s45, s31
    s_mov_b32 s46, 4096
    s_mov_b32 s47, 0x00020000
    s_add_u32 s3, s35, s37
    s_add_u32 s6, s34, s36
    v_add_u32 v8, s6, v2
    v_mul_u32_u24 v5, 1536, v8
    v_lshl_add_u32 v6, v3, 2, s3
    v_lshl_add_u32 v5, v6, 1, v5
    v_lshlrev_b32 v7, 1, v8
    buffer_load_dwordx2 v[128:129], v5, s[40:43], 0 offen offset:0
    buffer_load_dwordx2 v[130:131], v5, s[40:43], 0 offen offset:32
    buffer_load_dwordx2 v[132:133], v5, s[40:43], 0 offen offset:64
    buffer_load_ushort v140, v7, s[44:47], 0 offen offset:0
    v_add_u32 v5, 24576, v5
    buffer_load_dwordx2 v[134:135], v5, s[40:43], 0 offen offset:0
    buffer_load_dwordx2 v[136:137], v5, s[40:43], 0 offen offset:32
    buffer_load_dwordx2 v[138:139], v5, s[40:43], 0 offen offset:64
    buffer_load_ushort v141, v7, s[44:47], 0 offen offset:32
    v_lshrrev_b32 v6, 3, v6
    v_lshlrev_b32 v6, 15, v6
    v_lshl_add_u32 v6, v8, 4, v6
    v_and_b32 v7, 1, v3
    v_lshl_add_u32 v9, v7, 3, v6
    s_mov_b32 s19, 0
    s_mov_b32 s20, 16
    v_add_u32 v21, s19, v18
    v_add_u32 v22, s19, v19
    v_add_u32 v23, s19, v20
    s_mov_b32 s82, 0
    s_barrier
    ds_read_b128 v[24:27], v21 offset:0
    ds_read_b128 v[28:31], v21 offset:2048
    ds_read_b128 v[32:35], v23 offset:0
    ds_read_b128 v[36:39], v23 offset:256
    ds_read_b128 v[40:43], v23 offset:512
    ds_read_b128 v[44:47], v22 offset:0
    ds_read_b128 v[48:51], v22 offset:2048
    ds_read_b128 v[52:55], v23 offset:6144
    ds_read_b128 v[56:59], v23 offset:6400
    ds_read_b128 v[60:63], v23 offset:6656
    s_add_u32 s19, s19, 20480
    s_cmp_eq_u32 s19, 143360
    s_cselect_b32 s19, 0, s19
    v_add_u32 v21, s19, v18
    v_add_u32 v22, s19, v19
    v_add_u32 v23, s19, v20
    s_waitcnt lgkmcnt(0)
L_gemm2_0_kernel_loop:
    v_mfma_f32_16x16x32_bf16 v[104:107], v[32:35], v[24:27], v[104:107]
    ds_read_b128 v[64:67], v21 offset:0
    v_mfma_f32_16x16x32_bf16 v[108:111], v[36:39], v[24:27], v[108:111]
    ds_read_b128 v[68:71], v21 offset:2048
    v_mfma_f32_16x16x32_bf16 v[112:115], v[40:43], v[24:27], v[112:115]
    ds_read_b128 v[72:75], v23 offset:0
    v_mfma_f32_16x16x32_bf16 v[116:119], v[32:35], v[28:31], v[116:119]
    ds_read_b128 v[76:79], v23 offset:256
    v_mfma_f32_16x16x32_bf16 v[120:123], v[36:39], v[28:31], v[120:123]
    ds_read_b128 v[80:83], v23 offset:512
    v_mfma_f32_16x16x32_bf16 v[124:127], v[40:43], v[28:31], v[124:127]
    ds_read_b128 v[84:87], v22 offset:0
    v_mfma_f32_16x16x32_bf16 v[104:107], v[52:55], v[44:47], v[104:107]
    ds_read_b128 v[88:91], v22 offset:2048
    v_mfma_f32_16x16x32_bf16 v[108:111], v[56:59], v[44:47], v[108:111]
    ds_read_b128 v[92:95], v23 offset:6144
    v_mfma_f32_16x16x32_bf16 v[112:115], v[60:63], v[44:47], v[112:115]
    ds_read_b128 v[96:99], v23 offset:6400
    v_mfma_f32_16x16x32_bf16 v[116:119], v[52:55], v[48:51], v[116:119]
    ds_read_b128 v[100:103], v23 offset:6656
    v_mfma_f32_16x16x32_bf16 v[120:123], v[56:59], v[48:51], v[120:123]
    v_mfma_f32_16x16x32_bf16 v[124:127], v[60:63], v[48:51], v[124:127]
    s_add_u32 s19, s19, 20480
    s_cmp_eq_u32 s19, 143360
    s_cselect_b32 s19, 0, s19
    v_add_u32 v21, s19, v18
    v_add_u32 v22, s19, v19
    v_add_u32 v23, s19, v20
    s_waitcnt lgkmcnt(0)
    s_barrier
    v_mfma_f32_16x16x32_bf16 v[104:107], v[72:75], v[64:67], v[104:107]
    ds_read_b128 v[24:27], v21 offset:0
    v_mfma_f32_16x16x32_bf16 v[108:111], v[76:79], v[64:67], v[108:111]
    ds_read_b128 v[28:31], v21 offset:2048
    v_mfma_f32_16x16x32_bf16 v[112:115], v[80:83], v[64:67], v[112:115]
    ds_read_b128 v[32:35], v23 offset:0
    v_mfma_f32_16x16x32_bf16 v[116:119], v[72:75], v[68:71], v[116:119]
    ds_read_b128 v[36:39], v23 offset:256
    v_mfma_f32_16x16x32_bf16 v[120:123], v[76:79], v[68:71], v[120:123]
    ds_read_b128 v[40:43], v23 offset:512
    v_mfma_f32_16x16x32_bf16 v[124:127], v[80:83], v[68:71], v[124:127]
    ds_read_b128 v[44:47], v22 offset:0
    v_mfma_f32_16x16x32_bf16 v[104:107], v[92:95], v[84:87], v[104:107]
    ds_read_b128 v[48:51], v22 offset:2048
    v_mfma_f32_16x16x32_bf16 v[108:111], v[96:99], v[84:87], v[108:111]
    ds_read_b128 v[52:55], v23 offset:6144
    v_mfma_f32_16x16x32_bf16 v[112:115], v[100:103], v[84:87], v[112:115]
    ds_read_b128 v[56:59], v23 offset:6400
    v_mfma_f32_16x16x32_bf16 v[116:119], v[92:95], v[88:91], v[116:119]
    ds_read_b128 v[60:63], v23 offset:6656
    v_mfma_f32_16x16x32_bf16 v[120:123], v[96:99], v[88:91], v[120:123]
    v_mfma_f32_16x16x32_bf16 v[124:127], v[100:103], v[88:91], v[124:127]
    s_add_u32 s19, s19, 20480
    s_cmp_eq_u32 s19, 143360
    s_cselect_b32 s19, 0, s19
    v_add_u32 v21, s19, v18
    v_add_u32 v22, s19, v19
    v_add_u32 v23, s19, v20
    s_waitcnt lgkmcnt(0)
    s_barrier
    s_sub_u32 s20, s20, 1
    s_cmp_lg_u32 s20, 0
    s_cbranch_scc1 L_gemm2_0_kernel_loop
    s_nop 7
    s_nop 1
    s_waitcnt vmcnt(0) lgkmcnt(0)
    s_add_u32 s40, s4, 37748736
    s_addc_u32 s41, s5, 0
    s_mov_b32 s42, 3145728
    s_mov_b32 s43, 0x00020000
    v_lshlrev_b32 v140, 16, v140
    v_cvt_pk_bf16_f32 v146, v104, v105
    v_lshlrev_b32 v104, 16, v146
    v_and_b32 v105, 0xffff0000, v146
    v_cvt_pk_bf16_f32 v146, v106, v107
    v_lshlrev_b32 v106, 16, v146
    v_and_b32 v107, 0xffff0000, v146
    v_add_f32 v104, v104, v140
    v_add_f32 v105, v105, v140
    v_add_f32 v106, v106, v140
    v_add_f32 v107, v107, v140
    v_cvt_pk_bf16_f32 v146, v104, v105
    v_lshlrev_b32 v104, 16, v146
    v_and_b32 v105, 0xffff0000, v146
    v_cvt_pk_bf16_f32 v146, v106, v107
    v_lshlrev_b32 v106, 16, v146
    v_and_b32 v107, 0xffff0000, v146
    v_lshlrev_b32 v142, 16, v128
    v_and_b32 v143, 0xffff0000, v128
    v_lshlrev_b32 v144, 16, v129
    v_and_b32 v145, 0xffff0000, v129
    v_mul_f32 v104, v104, v142
    v_mul_f32 v105, v105, v143
    v_mul_f32 v106, v106, v144
    v_mul_f32 v107, v107, v145
    v_cvt_pk_bf16_f32 v104, v104, v105
    v_cvt_pk_bf16_f32 v105, v106, v107
    v_add_u32 v147, 0, v9
    buffer_store_dwordx2 v[104:105], v147, s[40:43], 0 offen
    v_cvt_pk_bf16_f32 v146, v108, v109
    v_lshlrev_b32 v108, 16, v146
    v_and_b32 v109, 0xffff0000, v146
    v_cvt_pk_bf16_f32 v146, v110, v111
    v_lshlrev_b32 v110, 16, v146
    v_and_b32 v111, 0xffff0000, v146
    v_add_f32 v108, v108, v140
    v_add_f32 v109, v109, v140
    v_add_f32 v110, v110, v140
    v_add_f32 v111, v111, v140
    v_cvt_pk_bf16_f32 v146, v108, v109
    v_lshlrev_b32 v108, 16, v146
    v_and_b32 v109, 0xffff0000, v146
    v_cvt_pk_bf16_f32 v146, v110, v111
    v_lshlrev_b32 v110, 16, v146
    v_and_b32 v111, 0xffff0000, v146
    v_lshlrev_b32 v142, 16, v130
    v_and_b32 v143, 0xffff0000, v130
    v_lshlrev_b32 v144, 16, v131
    v_and_b32 v145, 0xffff0000, v131
    v_mul_f32 v108, v108, v142
    v_mul_f32 v109, v109, v143
    v_mul_f32 v110, v110, v144
    v_mul_f32 v111, v111, v145
    v_cvt_pk_bf16_f32 v108, v108, v109
    v_cvt_pk_bf16_f32 v109, v110, v111
    v_add_u32 v147, 65536, v9
    buffer_store_dwordx2 v[108:109], v147, s[40:43], 0 offen
    v_cvt_pk_bf16_f32 v146, v112, v113
    v_lshlrev_b32 v112, 16, v146
    v_and_b32 v113, 0xffff0000, v146
    v_cvt_pk_bf16_f32 v146, v114, v115
    v_lshlrev_b32 v114, 16, v146
    v_and_b32 v115, 0xffff0000, v146
    v_add_f32 v112, v112, v140
    v_add_f32 v113, v113, v140
    v_add_f32 v114, v114, v140
    v_add_f32 v115, v115, v140
    v_cvt_pk_bf16_f32 v146, v112, v113
    v_lshlrev_b32 v112, 16, v146
    v_and_b32 v113, 0xffff0000, v146
    v_cvt_pk_bf16_f32 v146, v114, v115
    v_lshlrev_b32 v114, 16, v146
    v_and_b32 v115, 0xffff0000, v146
    v_lshlrev_b32 v142, 16, v132
    v_and_b32 v143, 0xffff0000, v132
    v_lshlrev_b32 v144, 16, v133
    v_and_b32 v145, 0xffff0000, v133
    v_mul_f32 v112, v112, v142
    v_mul_f32 v113, v113, v143
    v_mul_f32 v114, v114, v144
    v_mul_f32 v115, v115, v145
    v_cvt_pk_bf16_f32 v112, v112, v113
    v_cvt_pk_bf16_f32 v113, v114, v115
    v_add_u32 v147, 131072, v9
    buffer_store_dwordx2 v[112:113], v147, s[40:43], 0 offen
    v_lshlrev_b32 v141, 16, v141
    v_cvt_pk_bf16_f32 v146, v116, v117
    v_lshlrev_b32 v116, 16, v146
    v_and_b32 v117, 0xffff0000, v146
    v_cvt_pk_bf16_f32 v146, v118, v119
    v_lshlrev_b32 v118, 16, v146
    v_and_b32 v119, 0xffff0000, v146
    v_add_f32 v116, v116, v141
    v_add_f32 v117, v117, v141
    v_add_f32 v118, v118, v141
    v_add_f32 v119, v119, v141
    v_cvt_pk_bf16_f32 v146, v116, v117
    v_lshlrev_b32 v116, 16, v146
    v_and_b32 v117, 0xffff0000, v146
    v_cvt_pk_bf16_f32 v146, v118, v119
    v_lshlrev_b32 v118, 16, v146
    v_and_b32 v119, 0xffff0000, v146
    v_lshlrev_b32 v142, 16, v134
    v_and_b32 v143, 0xffff0000, v134
    v_lshlrev_b32 v144, 16, v135
    v_and_b32 v145, 0xffff0000, v135
    v_mul_f32 v116, v116, v142
    v_mul_f32 v117, v117, v143
    v_mul_f32 v118, v118, v144
    v_mul_f32 v119, v119, v145
    v_cvt_pk_bf16_f32 v116, v116, v117
    v_cvt_pk_bf16_f32 v117, v118, v119
    v_add_u32 v147, 256, v9
    buffer_store_dwordx2 v[116:117], v147, s[40:43], 0 offen
    v_cvt_pk_bf16_f32 v146, v120, v121
    v_lshlrev_b32 v120, 16, v146
    v_and_b32 v121, 0xffff0000, v146
    v_cvt_pk_bf16_f32 v146, v122, v123
    v_lshlrev_b32 v122, 16, v146
    v_and_b32 v123, 0xffff0000, v146
    v_add_f32 v120, v120, v141
    v_add_f32 v121, v121, v141
    v_add_f32 v122, v122, v141
    v_add_f32 v123, v123, v141
    v_cvt_pk_bf16_f32 v146, v120, v121
    v_lshlrev_b32 v120, 16, v146
    v_and_b32 v121, 0xffff0000, v146
    v_cvt_pk_bf16_f32 v146, v122, v123
    v_lshlrev_b32 v122, 16, v146
    v_and_b32 v123, 0xffff0000, v146
    v_lshlrev_b32 v142, 16, v136
    v_and_b32 v143, 0xffff0000, v136
    v_lshlrev_b32 v144, 16, v137
    v_and_b32 v145, 0xffff0000, v137
    v_mul_f32 v120, v120, v142
    v_mul_f32 v121, v121, v143
    v_mul_f32 v122, v122, v144
    v_mul_f32 v123, v123, v145
    v_cvt_pk_bf16_f32 v120, v120, v121
    v_cvt_pk_bf16_f32 v121, v122, v123
    v_add_u32 v147, 65792, v9
    buffer_store_dwordx2 v[120:121], v147, s[40:43], 0 offen
    v_cvt_pk_bf16_f32 v146, v124, v125
    v_lshlrev_b32 v124, 16, v146
    v_and_b32 v125, 0xffff0000, v146
    v_cvt_pk_bf16_f32 v146, v126, v127
    v_lshlrev_b32 v126, 16, v146
    v_and_b32 v127, 0xffff0000, v146
    v_add_f32 v124, v124, v141
    v_add_f32 v125, v125, v141
    v_add_f32 v126, v126, v141
    v_add_f32 v127, v127, v141
    v_cvt_pk_bf16_f32 v146, v124, v125
    v_lshlrev_b32 v124, 16, v146
    v_and_b32 v125, 0xffff0000, v146
    v_cvt_pk_bf16_f32 v146, v126, v127
    v_lshlrev_b32 v126, 16, v146
    v_and_b32 v127, 0xffff0000, v146
    v_lshlrev_b32 v142, 16, v138
    v_and_b32 v143, 0xffff0000, v138
    v_lshlrev_b32 v144, 16, v139
    v_and_b32 v145, 0xffff0000, v139
    v_mul_f32 v124, v124, v142
    v_mul_f32 v125, v125, v143
    v_mul_f32 v126, v126, v144
    v_mul_f32 v127, v127, v145
    v_cvt_pk_bf16_f32 v124, v124, v125
    v_cvt_pk_bf16_f32 v125, v126, v127
    v_add_u32 v147, 131328, v9
    buffer_store_dwordx2 v[124:125], v147, s[40:43], 0 offen
L_gemm2_0_kernel_end:
    s_endpgm
.globl gemm3_0_kernel
.p2align 8
.type gemm3_0_kernel,@function
gemm3_0_kernel:
    s_cmp_ge_u32 s2, 256
    s_cbranch_scc1 L_gemm3_0_kernel_end
    s_load_dwordx2 s[4:5], s[0:1], 104
    s_load_dwordx4 s[28:31], s[0:1], 64
    s_load_dwordx2 s[32:33], s[0:1], 88
    s_and_b32 s6, s2, 7
    s_lshr_b32 s7, s2, 3
    s_mul_i32 s22, s6, 4
    s_lshr_b32 s3, s7, 3
    s_add_u32 s22, s22, s3
    s_and_b32 s23, s7, 7
    v_and_b32 v1, 63, v0
    v_and_b32 v2, 15, v0
    v_bfe_u32 v3, v0, 4, 2
    v_lshrrev_b32 v4, 6, v0
    s_nop 0
    v_readfirstlane_b32 s21, v4
    s_mul_i32 s34, s22, 64
    s_mul_i32 s35, s23, 80
    s_cmp_lt_u32 s21, 4
    s_cbranch_scc1 L_gemm3_0_kernel_comp
    s_sub_u32 s21, s21, 4
    s_setprio 3
    s_mul_i32 s3, s21, 128
    s_add_u32 s3, s3, 0
    v_add_u32 v5, s3, v1
    v_lshrrev_b32 v6, 6, v5
    v_and_b32 v5, 63, v5
    v_mul_u32_u24 v6, 2048, v6
    v_add3_u32 v5, v5, v6, s34
    v_lshlrev_b32 v10, 4, v5
    s_mul_i32 s3, s21, 128
    s_add_u32 s3, s3, 64
    v_add_u32 v5, s3, v1
    v_lshrrev_b32 v6, 6, v5
    v_and_b32 v5, 63, v5
    v_mul_u32_u24 v6, 2048, v6
    v_add3_u32 v5, v5, v6, s34
    v_lshlrev_b32 v11, 4, v5
    s_lshl_b32 s3, s21, 6
    s_add_u32 s3, s3, 0
    v_add_u32 v5, s3, v1
    v_mul_u32_u24 v6, 205, v5
    v_lshrrev_b32 v6, 14, v6
    v_mul_u32_u24 v7, 80, v6
    v_sub_u32 v7, v5, v7
    v_mul_u32_u24 v6, 640, v6
    v_add3_u32 v7, v7, v6, s35
    v_lshlrev_b32 v14, 4, v7
    s_lshl_b32 s3, s21, 6
    s_add_u32 s3, s3, 256
    v_add_u32 v5, s3, v1
    v_mul_u32_u24 v6, 205, v5
    v_lshrrev_b32 v6, 14, v6
    v_mul_u32_u24 v7, 80, v6
    v_sub_u32 v7, v5, v7
    v_mul_u32_u24 v6, 640, v6
    v_add3_u32 v7, v7, v6, s35
    v_lshlrev_b32 v15, 4, v7
    s_lshl_b32 s3, s21, 6
    s_add_u32 s3, s3, 512
    v_add_u32 v5, s3, v1
    v_mul_u32_u24 v6, 205, v5
    v_lshrrev_b32 v6, 14, v6
    v_mul_u32_u24 v7, 80, v6
    v_sub_u32 v7, v5, v7
    v_mul_u32_u24 v6, 640, v6
    v_add3_u32 v7, v7, v6, s35
    v_lshlrev_b32 v16, 4, v7
    s_mul_i32 s24, s21, 2048
    s_lshl_b32 s25, s21, 10
    s_add_u32 s25, s25, 8192
    s_mov_b32 s16, 0
    s_mov_b32 s17, 0
    s_mov_b32 s18, 0
    s_waitcnt lgkmcnt(0)
    s_add_u32 s8, s4, 37748736
    s_addc_u32 s9, s5, 0
    s_mov_b32 s10, 3145728
    s_mov_b32 s11, 0x00020000
    s_add_u32 s12, s4, 12582912
    s_addc_u32 s13, s5, 0
    s_mov_b32 s14, 983040
    s_mov_b32 s15, 0x00020000
    s_cmp_lt_u32 s21, 2
    s_cbranch_scc0 L_gemm3_0_kernel_ld2
    s_add_u32 s26, s18, s24
    s_add_u32 s27, s18, s25
    s_add_u32 m0, s26, 0
    s_nop 0
    buffer_load_dwordx4 v10, s[8:11], s16 offen lds
    s_add_u32 m0, s26, 1024
    s_nop 0
    buffer_load_dwordx4 v11, s[8:11], s16 offen lds
    s_add_u32 m0, s27, 0
    s_nop 0
    buffer_load_dwordx4 v14, s[12:15], s17 offen lds
    s_add_u32 m0, s27, 4096
    s_nop 0
    buffer_load_dwordx4 v15, s[12:15], s17 offen lds
    s_add_u32 m0, s27, 8192
    s_nop 0
    buffer_load_dwordx4 v16, s[12:15], s17 offen lds
    s_add_u32 s16, s16, 262144
    s_add_u32 s17, s17, 81920
    s_add_u32 s18, s18, 20480
    s_cmp_eq_u32 s18, 143360
    s_cselect_b32 s18, 0, s18
    s_add_u32 s26, s18, s24
    s_add_u32 s27, s18, s25
    s_add_u32 m0, s26, 0
    s_nop 0
    buffer_load_dwordx4 v10, s[8:11], s16 offen lds
    s_add_u32 m0, s26, 1024
    s_nop 0
    buffer_load_dwordx4 v11, s[8:11], s16 offen lds
    s_add_u32 m0, s27, 0
    s_nop 0
    buffer_load_dwordx4 v14, s[12:15], s17 offen lds
    s_add_u32 m0, s27, 4096
    s_nop 0
    buffer_load_dwordx4 v15, s[12:15], s17 offen lds
    s_add_u32 m0, s27, 8192
    s_nop 0
    buffer_load_dwordx4 v16, s[12:15], s17 offen lds
    s_add_u32 s16, s16, 262144
    s_add_u32 s17, s17, 81920
    s_add_u32 s18, s18, 20480
    s_cmp_eq_u32 s18, 143360
    s_cselect_b32 s18, 0, s18
    s_add_u32 s26, s18, s24
    s_add_u32 s27, s18, s25
    s_add_u32 m0, s26, 0
    s_nop 0
    buffer_load_dwordx4 v10, s[8:11], s16 offen lds
    s_add_u32 m0, s26, 1024
    s_nop 0
    buffer_load_dwordx4 v11, s[8:11], s16 offen lds
    s_add_u32 m0, s27, 0
    s_nop 0
    buffer_load_dwordx4 v14, s[12:15], s17 offen lds
    s_add_u32 m0, s27, 4096
    s_nop 0
    buffer_load_dwordx4 v15, s[12:15], s17 offen lds
    s_add_u32 m0, s27, 8192
    s_nop 0
    buffer_load_dwordx4 v16, s[12:15], s17 offen lds
    s_add_u32 s16, s16, 262144
    s_add_u32 s17, s17, 81920
    s_add_u32 s18, s18, 20480
    s_cmp_eq_u32 s18, 143360
    s_cselect_b32 s18, 0, s18
    s_add_u32 s26, s18, s24
    s_add_u32 s27, s18, s25
    s_add_u32 m0, s26, 0
    s_nop 0
    buffer_load_dwordx4 v10, s[8:11], s16 offen lds
    s_add_u32 m0, s26, 1024
    s_nop 0
    buffer_load_dwordx4 v11, s[8:11], s16 offen lds
    s_add_u32 m0, s27, 0
    s_nop 0
    buffer_load_dwordx4 v14, s[12:15], s17 offen lds
    s_add_u32 m0, s27, 4096
    s_nop 0
    buffer_load_dwordx4 v15, s[12:15], s17 offen lds
    s_add_u32 m0, s27, 8192
    s_nop 0
    buffer_load_dwordx4 v16, s[12:15], s17 offen lds
    s_add_u32 s16, s16, 262144
    s_add_u32 s17, s17, 81920
    s_add_u32 s18, s18, 20480
    s_cmp_eq_u32 s18, 143360
    s_cselect_b32 s18, 0, s18
    s_waitcnt vmcnt(10)
    s_barrier
    s_add_u32 s26, s18, s24
    s_add_u32 s27, s18, s25
    s_add_u32 m0, s26, 0
    s_nop 0
    buffer_load_dwordx4 v10, s[8:11], s16 offen lds
    s_add_u32 m0, s26, 1024
    s_nop 0
    buffer_load_dwordx4 v11, s[8:11], s16 offen lds
    s_add_u32 m0, s27, 0
    s_nop 0
    buffer_load_dwordx4 v14, s[12:15], s17 offen lds
    s_add_u32 m0, s27, 4096
    s_nop 0
    buffer_load_dwordx4 v15, s[12:15], s17 offen lds
    s_add_u32 m0, s27, 8192
    s_nop 0
    buffer_load_dwordx4 v16, s[12:15], s17 offen lds
    s_add_u32 s16, s16, 262144
    s_add_u32 s17, s17, 81920
    s_add_u32 s18, s18, 20480
    s_cmp_eq_u32 s18, 143360
    s_cselect_b32 s18, 0, s18
    s_add_u32 s26, s18, s24
    s_add_u32 s27, s18, s25
    s_add_u32 m0, s26, 0
    s_nop 0
    buffer_load_dwordx4 v10, s[8:11], s16 offen lds
    s_add_u32 m0, s26, 1024
    s_nop 0
    buffer_load_dwordx4 v11, s[8:11], s16 offen lds
    s_add_u32 m0, s27, 0
    s_nop 0
    buffer_load_dwordx4 v14, s[12:15], s17 offen lds
    s_add_u32 m0, s27, 4096
    s_nop 0
    buffer_load_dwordx4 v15, s[12:15], s17 offen lds
    s_add_u32 m0, s27, 8192
    s_nop 0
    buffer_load_dwordx4 v16, s[12:15], s17 offen lds
    s_add_u32 s16, s16, 262144
    s_add_u32 s17, s17, 81920
    s_add_u32 s18, s18, 20480
    s_cmp_eq_u32 s18, 143360
    s_cselect_b32 s18, 0, s18
    s_waitcnt vmcnt(15)
    s_barrier
    s_add_u32 s26, s18, s24
    s_add_u32 s27, s18, s25
    s_add_u32 m0, s26, 0
    s_nop 0
    buffer_load_dwordx4 v10, s[8:11], s16 offen lds
    s_add_u32 m0, s26, 1024
    s_nop 0
    buffer_load_dwordx4 v11, s[8:11], s16 offen lds
    s_add_u32 m0, s27, 0
    s_nop 0
    buffer_load_dwordx4 v14, s[12:15], s17 offen lds
    s_add_u32 m0, s27, 4096
    s_nop 0
    buffer_load_dwordx4 v15, s[12:15], s17 offen lds
    s_add_u32 m0, s27, 8192
    s_nop 0
    buffer_load_dwordx4 v16, s[12:15], s17 offen lds
    s_add_u32 s16, s16, 262144
    s_add_u32 s17, s17, 81920
    s_add_u32 s18, s18, 20480
    s_cmp_eq_u32 s18, 143360
    s_cselect_b32 s18, 0, s18
    s_add_u32 s26, s18, s24
    s_add_u32 s27, s18, s25
    s_add_u32 m0, s26, 0
    s_nop 0
    buffer_load_dwordx4 v10, s[8:11], s16 offen lds
    s_add_u32 m0, s26, 1024
    s_nop 0
    buffer_load_dwordx4 v11, s[8:11], s16 offen lds
    s_add_u32 m0, s27, 0
    s_nop 0
    buffer_load_dwordx4 v14, s[12:15], s17 offen lds
    s_add_u32 m0, s27, 4096
    s_nop 0
    buffer_load_dwordx4 v15, s[12:15], s17 offen lds
    s_add_u32 m0, s27, 8192
    s_nop 0
    buffer_load_dwordx4 v16, s[12:15], s17 offen lds
    s_add_u32 s16, s16, 262144
    s_add_u32 s17, s17, 81920
    s_add_u32 s18, s18, 20480
    s_cmp_eq_u32 s18, 143360
    s_cselect_b32 s18, 0, s18
    s_waitcnt vmcnt(20)
    s_barrier
    s_add_u32 s26, s18, s24
    s_add_u32 s27, s18, s25
    s_add_u32 m0, s26, 0
    s_nop 0
    buffer_load_dwordx4 v10, s[8:11], s16 offen lds
    s_add_u32 m0, s26, 1024
    s_nop 0
    buffer_load_dwordx4 v11, s[8:11], s16 offen lds
    s_add_u32 m0, s27, 0
    s_nop 0
    buffer_load_dwordx4 v14, s[12:15], s17 offen lds
    s_add_u32 m0, s27, 4096
    s_nop 0
    buffer_load_dwordx4 v15, s[12:15], s17 offen lds
    s_add_u32 m0, s27, 8192
    s_nop 0
    buffer_load_dwordx4 v16, s[12:15], s17 offen lds
    s_add_u32 s16, s16, 262144
    s_add_u32 s17, s17, 81920
    s_add_u32 s18, s18, 20480
    s_cmp_eq_u32 s18, 143360
    s_cselect_b32 s18, 0, s18
    s_add_u32 s26, s18, s24
    s_add_u32 s27, s18, s25
    s_add_u32 m0, s26, 0
    s_nop 0
    buffer_load_dwordx4 v10, s[8:11], s16 offen lds
    s_add_u32 m0, s26, 1024
    s_nop 0
    buffer_load_dwordx4 v11, s[8:11], s16 offen lds
    s_add_u32 m0, s27, 0
    s_nop 0
    buffer_load_dwordx4 v14, s[12:15], s17 offen lds
    s_add_u32 m0, s27, 4096
    s_nop 0
    buffer_load_dwordx4 v15, s[12:15], s17 offen lds
    s_add_u32 m0, s27, 8192
    s_nop 0
    buffer_load_dwordx4 v16, s[12:15], s17 offen lds
    s_add_u32 s16, s16, 262144
    s_add_u32 s17, s17, 81920
    s_add_u32 s18, s18, 20480
    s_cmp_eq_u32 s18, 143360
    s_cselect_b32 s18, 0, s18
    s_mov_b32 s20, 2
L_gemm3_0_kernel_lloopa:
    s_waitcnt vmcnt(25)
    s_barrier
    s_add_u32 s26, s18, s24
    s_add_u32 s27, s18, s25
    s_add_u32 m0, s26, 0
    s_nop 0
    buffer_load_dwordx4 v10, s[8:11], s16 offen lds
    s_add_u32 m0, s26, 1024
    s_nop 0
    buffer_load_dwordx4 v11, s[8:11], s16 offen lds
    s_add_u32 m0, s27, 0
    s_nop 0
    buffer_load_dwordx4 v14, s[12:15], s17 offen lds
    s_add_u32 m0, s27, 4096
    s_nop 0
    buffer_load_dwordx4 v15, s[12:15], s17 offen lds
    s_add_u32 m0, s27, 8192
    s_nop 0
    buffer_load_dwordx4 v16, s[12:15], s17 offen lds
    s_add_u32 s16, s16, 262144
    s_add_u32 s17, s17, 81920
    s_add_u32 s18, s18, 20480
    s_cmp_eq_u32 s18, 143360
    s_cselect_b32 s18, 0, s18
    s_sub_u32 s20, s20, 1
    s_cmp_lg_u32 s20, 0
    s_cbranch_scc1 L_gemm3_0_kernel_lloopa
    s_waitcnt vmcnt(25)
    s_barrier
    s_waitcnt vmcnt(20)
    s_barrier
    s_waitcnt vmcnt(15)
    s_barrier
    s_waitcnt vmcnt(10)
    s_barrier
    s_waitcnt vmcnt(5)
    s_barrier
    s_waitcnt vmcnt(0)
    s_barrier
    s_waitcnt vmcnt(0)
    s_barrier
    s_waitcnt vmcnt(0)
    s_barrier
    s_cmp_ge_u32 s2, 8
    s_cbranch_scc1 L_cpf_6
    v_lshlrev_b32 v5, 4, v0
    s_getpc_b64 s[100:101]
L_cpfpc_6_0:
    s_add_u32 s100, s100, lnx1_kernel-L_cpfpc_6_0
    s_addc_u32 s101, s101, (lnx1_kernel-L_cpfpc_6_0)>>32
    v_cmp_gt_u32 vcc, L_text_end-lnx1_kernel-16, v5
    s_and_saveexec_b64 s[98:99], vcc
    global_load_dwordx4 v[24:27], v5, s[100:101]
    s_mov_b64 exec, s[98:99]
L_cpf_6:
    s_branch L_gemm3_0_kernel_end
L_gemm3_0_kernel_ld2:
    s_add_u32 s26, s18, s24
    s_add_u32 s27, s18, s25
    s_add_u32 m0, s26, 0
    s_nop 0
    buffer_load_dwordx4 v10, s[8:11], s16 offen lds
    s_add_u32 m0, s26, 1024
    s_nop 0
    buffer_load_dwordx4 v11, s[8:11], s16 offen lds
    s_add_u32 m0, s27, 0
    s_nop 0
    buffer_load_dwordx4 v14, s[12:15], s17 offen lds
    s_add_u32 m0, s27, 4096
    s_nop 0
    buffer_load_dwordx4 v15, s[12:15], s17 offen lds
    s_add_u32 s16, s16, 262144
    s_add_u32 s17, s17, 81920
    s_add_u32 s18, s18, 20480
    s_cmp_eq_u32 s18, 143360
    s_cselect_b32 s18, 0, s18
    s_add_u32 s26, s18, s24
    s_add_u32 s27, s18, s25
    s_add_u32 m0, s26, 0
    s_nop 0
    buffer_load_dwordx4 v10, s[8:11], s16 offen lds
    s_add_u32 m0, s26, 1024
    s_nop 0
    buffer_load_dwordx4 v11, s[8:11], s16 offen lds
    s_add_u32 m0, s27, 0
    s_nop 0
    buffer_load_dwordx4 v14, s[12:15], s17 offen lds
    s_add_u32 m0, s27, 4096
    s_nop 0
    buffer_load_dwordx4 v15, s[12:15], s17 offen lds
    s_add_u32 s16, s16, 262144
    s_add_u32 s17, s17, 81920
    s_add_u32 s18, s18, 20480
    s_cmp_eq_u32 s18, 143360
    s_cselect_b32 s18, 0, s18
    s_add_u32 s26, s18, s24
    s_add_u32 s27, s18, s25
    s_add_u32 m0, s26, 0
    s_nop 0
    buffer_load_dwordx4 v10, s[8:11], s16 offen lds
    s_add_u32 m0, s26, 1024
    s_nop 0
    buffer_load_dwordx4 v11, s[8:11], s16 offen lds
    s_add_u32 m0, s27, 0
    s_nop 0
    buffer_load_dwordx4 v14, s[12:15], s17 offen lds
    s_add_u32 m0, s27, 4096
    s_nop 0
    buffer_load_dwordx4 v15, s[12:15], s17 offen lds
    s_add_u32 s16, s16, 262144
    s_add_u32 s17, s17, 81920
    s_add_u32 s18, s18, 20480
    s_cmp_eq_u32 s18, 143360
    s_cselect_b32 s18, 0, s18
    s_add_u32 s26, s18, s24
    s_add_u32 s27, s18, s25
    s_add_u32 m0, s26, 0
    s_nop 0
    buffer_load_dwordx4 v10, s[8:11], s16 offen lds
    s_add_u32 m0, s26, 1024
    s_nop 0
    buffer_load_dwordx4 v11, s[8:11], s16 offen lds
    s_add_u32 m0, s27, 0
    s_nop 0
    buffer_load_dwordx4 v14, s[12:15], s17 offen lds
    s_add_u32 m0, s27, 4096
    s_nop 0
    buffer_load_dwordx4 v15, s[12:15], s17 offen lds
    s_add_u32 s16, s16, 262144
    s_add_u32 s17, s17, 81920
    s_add_u32 s18, s18, 20480
    s_cmp_eq_u32 s18, 143360
    s_cselect_b32 s18, 0, s18
    s_waitcnt vmcnt(8)
    s_barrier
    s_add_u32 s26, s18, s24
    s_add_u32 s27, s18, s25
    s_add_u32 m0, s26, 0
    s_nop 0
    buffer_load_dwordx4 v10, s[8:11], s16 offen lds
    s_add_u32 m0, s26, 1024
    s_nop 0
    buffer_load_dwordx4 v11, s[8:11], s16 offen lds
    s_add_u32 m0, s27, 0
    s_nop 0
    buffer_load_dwordx4 v14, s[12:15], s17 offen lds
    s_add_u32 m0, s27, 4096
    s_nop 0
    buffer_load_dwordx4 v15, s[12:15], s17 offen lds
    s_add_u32 s16, s16, 262144
    s_add_u32 s17, s17, 81920
    s_add_u32 s18, s18, 20480
    s_cmp_eq_u32 s18, 143360
    s_cselect_b32 s18, 0, s18
    s_add_u32 s26, s18, s24
    s_add_u32 s27, s18, s25
    s_add_u32 m0, s26, 0
    s_nop 0
    buffer_load_dwordx4 v10, s[8:11], s16 offen lds
    s_add_u32 m0, s26, 1024
    s_nop 0
    buffer_load_dwordx4 v11, s[8:11], s16 offen lds
    s_add_u32 m0, s27, 0
    s_nop 0
    buffer_load_dwordx4 v14, s[12:15], s17 offen lds
    s_add_u32 m0, s27, 4096
    s_nop 0
    buffer_load_dwordx4 v15, s[12:15], s17 offen lds
    s_add_u32 s16, s16, 262144
    s_add_u32 s17, s17, 81920
    s_add_u32 s18, s18, 20480
    s_cmp_eq_u32 s18, 143360
    s_cselect_b32 s18, 0, s18
    s_waitcnt vmcnt(12)
    s_barrier
    s_add_u32 s26, s18, s24
    s_add_u32 s27, s18, s25
    s_add_u32 m0, s26, 0
    s_nop 0
    buffer_load_dwordx4 v10, s[8:11], s16 offen lds
    s_add_u32 m0, s26, 1024
    s_nop 0
    buffer_load_dwordx4 v11, s[8:11], s16 offen lds
    s_add_u32 m0, s27, 0
    s_nop 0
    buffer_load_dwordx4 v14, s[12:15], s17 offen lds
    s_add_u32 m0, s27, 4096
    s_nop 0
    buffer_load_dwordx4 v15, s[12:15], s17 offen lds
    s_add_u32 s16, s16, 262144
    s_add_u32 s17, s17, 81920
    s_add_u32 s18, s18, 20480
    s_cmp_eq_u32 s18, 143360
    s_cselect_b32 s18, 0, s18
    s_add_u32 s26, s18, s24
    s_add_u32 s27, s18, s25
    s_add_u32 m0, s26, 0
    s_nop 0
    buffer_load_dwordx4 v10, s[8:11], s16 offen lds
    s_add_u32 m0, s26, 1024
    s_nop 0
    buffer_load_dwordx4 v11, s[8:11], s16 offen lds
    s_add_u32 m0, s27, 0
    s_nop 0
    buffer_load_dwordx4 v14, s[12:15], s17 offen lds
    s_add_u32 m0, s27, 4096
    s_nop 0
    buffer_load_dwordx4 v15, s[12:15], s17 offen lds
    s_add_u32 s16, s16, 262144
    s_add_u32 s17, s17, 81920
    s_add_u32 s18, s18, 20480
    s_cmp_eq_u32 s18, 143360
    s_cselect_b32 s18, 0, s18
    s_waitcnt vmcnt(16)
    s_barrier
    s_add_u32 s26, s18, s24
    s_add_u32 s27, s18, s25
    s_add_u32 m0, s26, 0
    s_nop 0
    buffer_load_dwordx4 v10, s[8:11], s16 offen lds
    s_add_u32 m0, s26, 1024
    s_nop 0
    buffer_load_dwordx4 v11, s[8:11], s16 offen lds
    s_add_u32 m0, s27, 0
    s_nop 0
    buffer_load_dwordx4 v14, s[12:15], s17 offen lds
    s_add_u32 m0, s27, 4096
    s_nop 0
    buffer_load_dwordx4 v15, s[12:15], s17 offen lds
    s_add_u32 s16, s16, 262144
    s_add_u32 s17, s17, 81920
    s_add_u32 s18, s18, 20480
    s_cmp_eq_u32 s18, 143360
    s_cselect_b32 s18, 0, s18
    s_add_u32 s26, s18, s24
    s_add_u32 s27, s18, s25
    s_add_u32 m0, s26, 0
    s_nop 0
    buffer_load_dwordx4 v10, s[8:11], s16 offen lds
    s_add_u32 m0, s26, 1024
    s_nop 0
    buffer_load_dwordx4 v11, s[8:11], s16 offen lds
    s_add_u32 m0, s27, 0
    s_nop 0
    buffer_load_dwordx4 v14, s[12:15], s17 offen lds
    s_add_u32 m0, s27, 4096
    s_nop 0
    buffer_load_dwordx4 v15, s[12:15], s17 offen lds
    s_add_u32 s16, s16, 262144
    s_add_u32 s17, s17, 81920
    s_add_u32 s18, s18, 20480
    s_cmp_eq_u32 s18, 143360
    s_cselect_b32 s18, 0, s18
    s_mov_b32 s20, 2
L_gemm3_0_kernel_lloopb:
    s_waitcnt vmcnt(20)
    s_barrier
    s_add_u32 s26, s18, s24
    s_add_u32 s27, s18, s25
    s_add_u32 m0, s26, 0
    s_nop 0
    buffer_load_dwordx4 v10, s[8:11], s16 offen lds
    s_add_u32 m0, s26, 1024
    s_nop 0
    buffer_load_dwordx4 v11, s[8:11], s16 offen lds
    s_add_u32 m0, s27, 0
    s_nop 0
    buffer_load_dwordx4 v14, s[12:15], s17 offen lds
    s_add_u32 m0, s27, 4096
    s_nop 0
    buffer_load_dwordx4 v15, s[12:15], s17 offen lds
    s_add_u32 s16, s16, 262144
    s_add_u32 s17, s17, 81920
    s_add_u32 s18, s18, 20480
    s_cmp_eq_u32 s18, 143360
    s_cselect_b32 s18, 0, s18
    s_sub_u32 s20, s20, 1
    s_cmp_lg_u32 s20, 0
    s_cbranch_scc1 L_gemm3_0_kernel_lloopb
    s_waitcnt vmcnt(20)
    s_barrier
    s_waitcnt vmcnt(16)
    s_barrier
    s_waitcnt vmcnt(12)
    s_barrier
    s_waitcnt vmcnt(8)
    s_barrier
    s_waitcnt vmcnt(4)
    s_barrier
    s_waitcnt vmcnt(0)
    s_barrier
    s_waitcnt vmcnt(0)
    s_barrier
    s_waitcnt vmcnt(0)
    s_barrier
    s_cmp_ge_u32 s2, 8
    s_cbranch_scc1 L_cpf_7
    v_lshlrev_b32 v5, 4, v0
    s_getpc_b64 s[100:101]
L_cpfpc_7_0:
    s_add_u32 s100, s100, lnx1_kernel-L_cpfpc_7_0
    s_addc_u32 s101, s101, (lnx1_kernel-L_cpfpc_7_0)>>32
    v_cmp_gt_u32 vcc, L_text_end-lnx1_kernel-16, v5
    s_and_saveexec_b64 s[98:99], vcc
    global_load_dwordx4 v[24:27], v5, s[100:101]
    s_mov_b64 exec, s[98:99]
L_cpf_7:
    s_branch L_gemm3_0_kernel_end
L_gemm3_0_kernel_comp:
    s_mov_b32 s36, s21
    s_mov_b32 s37, 0
    s_mul_i32 s36, s36, 16
    s_mul_i32 s37, s37, 80
    v_mul_u32_u24 v5, 64, v3
    v_add3_u32 v5, v5, v2, s36
    v_lshlrev_b32 v18, 4, v5
    v_mul_u32_u24 v5, 80, v3
    v_add3_u32 v5, v5, v2, s37
    v_lshlrev_b32 v5, 4, v5
    v_add_u32 v20, 8192, v5
    v_mov_b32 v120, 0
    v_mov_b32 v121, 0
    v_mov_b32 v122, 0
    v_mov_b32 v123, 0
    v_mov_b32 v124, 0
    v_mov_b32 v125, 0
    v_mov_b32 v126, 0
    v_mov_b32 v127, 0
    v_mov_b32 v128, 0
    v_mov_b32 v129, 0
    v_mov_b32 v130, 0
    v_mov_b32 v131, 0
    v_mov_b32 v132, 0
    v_mov_b32 v133, 0
    v_mov_b32 v134, 0
    v_mov_b32 v135, 0
    v_mov_b32 v136, 0
    v_mov_b32 v137, 0
    v_mov_b32 v138, 0
    v_mov_b32 v139, 0
    s_waitcnt lgkmcnt(0)
    s_add_u32 s40, s4, 16777216
    s_addc_u32 s41, s5, 0
    s_mov_b32 s42, 2621440
    s_mov_b32 s43, 0x00020000
    s_add_u32 s3, s35, s37
    s_add_u32 s6, s34, s36
    v_add_u32 v8, s6, v2
    v_mul_u32_u24 v5, 1280, v8
    v_lshl_add_u32 v6, v3, 2, s3
    v_lshl_add_u32 v9, v6, 1, v5
    buffer_load_dwordx2 v[140:141], v9, s[40:43], 0 offen offset:0
    buffer_load_dwordx2 v[142:143], v9, s[40:43], 0 offen offset:32
    buffer_load_dwordx2 v[144:145], v9, s[40:43], 0 offen offset:64
    buffer_load_dwordx2 v[146:147], v9, s[40:43], 0 offen offset:96
    buffer_load_dwordx2 v[148:149], v9, s[40:43], 0 offen offset:128
    s_mov_b32 s19, 0
    s_mov_b32 s20, 6
    v_add_u32 v21, s19, v18
    v_add_u32 v23, s19, v20
    s_mov_b32 s82, 0
    s_barrier
    ds_read_b128 v[24:27], v21 offset:0
    ds_read_b128 v[28:31], v23 offset:0
    ds_read_b128 v[32:35], v23 offset:256
    ds_read_b128 v[36:39], v23 offset:512
    ds_read_b128 v[40:43], v23 offset:768
    ds_read_b128 v[44:47], v23 offset:1024
    ds_read_b128 v[48:51], v21 offset:4096
    ds_read_b128 v[52:55], v23 offset:5120
    ds_read_b128 v[56:59], v23 offset:5376
    ds_read_b128 v[60:63], v23 offset:5632
    ds_read_b128 v[64:67], v23 offset:5888
    ds_read_b128 v[68:71], v23 offset:6144
    s_add_u32 s19, s19, 20480
    s_cmp_eq_u32 s19, 143360
    s_cselect_b32 s19, 0, s19
    v_add_u32 v21, s19, v18
    v_add_u32 v23, s19, v20
    s_waitcnt lgkmcnt(0)
L_gemm3_0_kernel_loop:
    v_mfma_f32_16x16x32_bf16 v[120:123], v[28:31], v[24:27], v[120:123]
    ds_read_b128 v[72:75], v21 offset:0
    v_mfma_f32_16x16x32_bf16 v[124:127], v[32:35], v[24:27], v[124:127]
    ds_read_b128 v[76:79], v23 offset:0
    v_mfma_f32_16x16x32_bf16 v[128:131], v[36:39], v[24:27], v[128:131]
    ds_read_b128 v[80:83], v23 offset:256
    v_mfma_f32_16x16x32_bf16 v[132:135], v[40:43], v[24:27], v[132:135]
    ds_read_b128 v[84:87], v23 offset:512
    v_mfma_f32_16x16x32_bf16 v[136:139], v[44:47], v[24:27], v[136:139]
    ds_read_b128 v[88:91], v23 offset:768
    v_mfma_f32_16x16x32_bf16 v[120:123], v[52:55], v[48:51], v[120:123]
    ds_read_b128 v[92:95], v23 offset:1024
    v_mfma_f32_16x16x32_bf16 v[124:127], v[56:59], v[48:51], v[124:127]
    ds_read_b128 v[96:99], v21 offset:4096
    v_mfma_f32_16x16x32_bf16 v[128:131], v[60:63], v[48:51], v[128:131]
    ds_read_b128 v[100:103], v23 offset:5120
    v_mfma_f32_16x16x32_bf16 v[132:135], v[64:67], v[48:51], v[132:135]
    ds_read_b128 v[104:107], v23 offset:5376
    v_mfma_f32_16x16x32_bf16 v[136:139], v[68:71], v[48:51], v[136:139]
    ds_read_b128 v[108:111], v23 offset:5632
    ds_read_b128 v[112:115], v23 offset:5888
    ds_read_b128 v[116:119], v23 offset:6144
    s_add_u32 s19, s19, 20480
    s_cmp_eq_u32 s19, 143360
    s_cselect_b32 s19, 0, s19
    v_add_u32 v21, s19, v18
    v_add_u32 v23, s19, v20
    s_waitcnt lgkmcnt(0)
    s_barrier
    v_mfma_f32_16x16x32_bf16 v[120:123], v[76:79], v[72:75], v[120:123]
    ds_read_b128 v[24:27], v21 offset:0
    v_mfma_f32_16x16x32_bf16 v[124:127], v[80:83], v[72:75], v[124:127]
    ds_read_b128 v[28:31], v23 offset:0
    v_mfma_f32_16x16x32_bf16 v[128:131], v[84:87], v[72:75], v[128:131]
    ds_read_b128 v[32:35], v23 offset:256
    v_mfma_f32_16x16x32_bf16 v[132:135], v[88:91], v[72:75], v[132:135]
    ds_read_b128 v[36:39], v23 offset:512
    v_mfma_f32_16x16x32_bf16 v[136:139], v[92:95], v[72:75], v[136:139]
    ds_read_b128 v[40:43], v23 offset:768
    v_mfma_f32_16x16x32_bf16 v[120:123], v[100:103], v[96:99], v[120:123]
    ds_read_b128 v[44:47], v23 offset:1024
    v_mfma_f32_16x16x32_bf16 v[124:127], v[104:107], v[96:99], v[124:127]
    ds_read_b128 v[48:51], v21 offset:4096
    v_mfma_f32_16x16x32_bf16 v[128:131], v[108:111], v[96:99], v[128:131]
    ds_read_b128 v[52:55], v23 offset:5120
    v_mfma_f32_16x16x32_bf16 v[132:135], v[112:115], v[96:99], v[132:135]
    ds_read_b128 v[56:59], v23 offset:5376
    v_mfma_f32_16x16x32_bf16 v[136:139], v[116:119], v[96:99], v[136:139]
    ds_read_b128 v[60:63], v23 offset:5632
    ds_read_b128 v[64:67], v23 offset:5888
    ds_read_b128 v[68:71], v23 offset:6144
    s_add_u32 s19, s19, 20480
    s_cmp_eq_u32 s19, 143360
    s_cselect_b32 s19, 0, s19
    v_add_u32 v21, s19, v18
    v_add_u32 v23, s19, v20
    s_waitcnt lgkmcnt(0)
    s_barrier
    s_sub_u32 s20, s20, 1
    s_cmp_lg_u32 s20, 0
    s_cbranch_scc1 L_gemm3_0_kernel_loop
    s_nop 7
    s_nop 1
    s_waitcnt vmcnt(0) lgkmcnt(0)
    s_add_u32 s40, s4, 41943040
    s_addc_u32 s41, s5, 0
    s_mov_b32 s42, 2621440
    s_mov_b32 s43, 0x00020000
    v_cvt_pk_bf16_f32 v154, v120, v121
    v_lshlrev_b32 v120, 16, v154
    v_and_b32 v121, 0xffff0000, v154
    v_cvt_pk_bf16_f32 v154, v122, v123
    v_lshlrev_b32 v122, 16, v154
    v_and_b32 v123, 0xffff0000, v154
    v_lshlrev_b32 v150, 16, v140
    v_and_b32 v151, 0xffff0000, v140
    v_lshlrev_b32 v152, 16, v141
    v_and_b32 v153, 0xffff0000, v141
    v_add_f32 v120, v120, v150
    v_add_f32 v121, v121, v151
    v_add_f32 v122, v122, v152
    v_add_f32 v123, v123, v153
    v_cvt_pk_bf16_f32 v120, v120, v121
    v_cvt_pk_bf16_f32 v121, v122, v123
    buffer_store_dwordx2 v[120:121], v9, s[40:43], 0 offen offset:0
    v_cvt_pk_bf16_f32 v154, v124, v125
    v_lshlrev_b32 v124, 16, v154
    v_and_b32 v125, 0xffff0000, v154
    v_cvt_pk_bf16_f32 v154, v126, v127
    v_lshlrev_b32 v126, 16, v154
    v_and_b32 v127, 0xffff0000, v154
    v_lshlrev_b32 v150, 16, v142
    v_and_b32 v151, 0xffff0000, v142
    v_lshlrev_b32 v152, 16, v143
    v_and_b32 v153, 0xffff0000, v143
    v_add_f32 v124, v124, v150
    v_add_f32 v125, v125, v151
    v_add_f32 v126, v126, v152
    v_add_f32 v127, v127, v153
    v_cvt_pk_bf16_f32 v124, v124, v125
    v_cvt_pk_bf16_f32 v125, v126, v127
    buffer_store_dwordx2 v[124:125], v9, s[40:43], 0 offen offset:32
    v_cvt_pk_bf16_f32 v154, v128, v129
    v_lshlrev_b32 v128, 16, v154
    v_and_b32 v129, 0xffff0000, v154
    v_cvt_pk_bf16_f32 v154, v130, v131
    v_lshlrev_b32 v130, 16, v154
    v_and_b32 v131, 0xffff0000, v154
    v_lshlrev_b32 v150, 16, v144
    v_and_b32 v151, 0xffff0000, v144
    v_lshlrev_b32 v152, 16, v145
    v_and_b32 v153, 0xffff0000, v145
    v_add_f32 v128, v128, v150
    v_add_f32 v129, v129, v151
    v_add_f32 v130, v130, v152
    v_add_f32 v131, v131, v153
    v_cvt_pk_bf16_f32 v128, v128, v129
    v_cvt_pk_bf16_f32 v129, v130, v131
    buffer_store_dwordx2 v[128:129], v9, s[40:43], 0 offen offset:64
    v_cvt_pk_bf16_f32 v154, v132, v133
    v_lshlrev_b32 v132, 16, v154
    v_and_b32 v133, 0xffff0000, v154
    v_cvt_pk_bf16_f32 v154, v134, v135
    v_lshlrev_b32 v134, 16, v154
    v_and_b32 v135, 0xffff0000, v154
    v_lshlrev_b32 v150, 16, v146
    v_and_b32 v151, 0xffff0000, v146
    v_lshlrev_b32 v152, 16, v147
    v_and_b32 v153, 0xffff0000, v147
    v_add_f32 v132, v132, v150
    v_add_f32 v133, v133, v151
    v_add_f32 v134, v134, v152
    v_add_f32 v135, v135, v153
    v_cvt_pk_bf16_f32 v132, v132, v133
    v_cvt_pk_bf16_f32 v133, v134, v135
    buffer_store_dwordx2 v[132:133], v9, s[40:43], 0 offen offset:96
    v_cvt_pk_bf16_f32 v154, v136, v137
    v_lshlrev_b32 v136, 16, v154
    v_and_b32 v137, 0xffff0000, v154
    v_cvt_pk_bf16_f32 v154, v138, v139
    v_lshlrev_b32 v138, 16, v154
    v_and_b32 v139, 0xffff0000, v154
    v_lshlrev_b32 v150, 16, v148
    v_and_b32 v151, 0xffff0000, v148
    v_lshlrev_b32 v152, 16, v149
    v_and_b32 v153, 0xffff0000, v149
    v_add_f32 v136, v136, v150
    v_add_f32 v137, v137, v151
    v_add_f32 v138, v138, v152
    v_add_f32 v139, v139, v153
    v_cvt_pk_bf16_f32 v136, v136, v137
    v_cvt_pk_bf16_f32 v137, v138, v139
    buffer_store_dwordx2 v[136:137], v9, s[40:43], 0 offen offset:128
L_gemm3_0_kernel_end:
    s_endpgm
.globl lnx1_kernel
.p2align 8
.type lnx1_kernel,@function
lnx1_kernel:
    s_cmp_ge_u32 s2, 256
    s_cbranch_scc1 L_lnx1_kernel_end
    s_cmp_ge_u32 s2, 8
    s_cbranch_scc1 L_cpf_8
    v_lshlrev_b32 v1, 4, v0
    s_getpc_b64 s[100:101]
L_cpfpc_8_0:
    s_add_u32 s100, s100, gemm1_0_kernel-L_cpfpc_8_0
    s_addc_u32 s101, s101, (gemm1_0_kernel-L_cpfpc_8_0)>>32
    v_cmp_gt_u32 vcc, L_text_end-gemm1_0_kernel-16, v1
    s_and_saveexec_b64 s[98:99], vcc
    global_load_dwordx4 v[92:95], v1, s[100:101]
    s_mov_b64 exec, s[98:99]
L_cpf_8:
    s_load_dwordx2 s[4:5], s[0:1], 104
    s_load_dwordx2 s[6:7], s[0:1], 0
    s_and_b32 s3, s2, 7
    s_lshl_b32 s3, s3, 5
    s_lshr_b32 s2, s2, 3
    s_add_u32 s2, s2, s3
    v_and_b32 v1, 63, v0
    v_lshrrev_b32 v2, 6, v0
    s_lshl_b32 s3, s2, 3
    s_lshl_b32 s24, s2, 4
    v_mul_u32_u24 v3, 4224, v0
    v_add_u32 v4, 2162688, v3
    v_add_u32 v5, s3, v2
    v_mul_u32_u24 v8, 1280, v5
    v_lshl_add_u32 v6, v1, 4, v8
    v_lshl_add_u32 v8, v1, 2, v8
    s_waitcnt lgkmcnt(0)
    s_add_u32 s8, s4, 41943040
    s_addc_u32 s9, s5, 0
    s_mov_b32 s10, 2621440
    s_mov_b32 s11, 0x00020000
    s_add_u32 s12, s4, 46137344
    s_addc_u32 s13, s5, 0
    s_mov_b32 s14, 2621440
    s_mov_b32 s15, 0x00020000
    buffer_load_dwordx4 v[48:51], v6, s[8:11], 0 offen
    buffer_load_dword v52, v8, s[8:11], 0 offen offset:1024
    buffer_load_dwordx4 v[40:43], v6, s[12:15], 0 offen
    buffer_load_dword v44, v8, s[12:15], 0 offen offset:1024
    s_add_u32 s16, s4, 16777216
    s_addc_u32 s17, s5, 0
    s_mov_b32 s18, 2621440
    s_mov_b32 s19, 0x00020000
    s_add_u32 s20, s4, 20971520
    s_addc_u32 s21, s5, 0
    s_mov_b32 s22, 2621440
    s_mov_b32 s23, 0x00020000
    s_waitcnt vmcnt(2)
    v_lshlrev_b32 v60, 16, v48
    v_and_b32 v61, 0xffff0000, v48
    v_lshlrev_b32 v62, 16, v49
    v_and_b32 v63, 0xffff0000, v49
    v_lshlrev_b32 v64, 16, v50
    v_and_b32 v65, 0xffff0000, v50
    v_lshlrev_b32 v66, 16, v51
    v_and_b32 v67, 0xffff0000, v51
    v_lshlrev_b32 v68, 16, v52
    v_and_b32 v69, 0xffff0000, v52
    v_pk_add_f32 v[10:11], v[60:61], v[62:63]
    v_pk_add_f32 v[10:11], v[10:11], v[64:65]
    v_pk_add_f32 v[10:11], v[10:11], v[66:67]
    v_pk_add_f32 v[10:11], v[10:11], v[68:69]
    v_add_f32 v10, v10, v11
    s_nop 1
    v_add_f32_dpp v10, v10, v10 row_shr:1 row_mask:0xf bank_mask:0xf bound_ctrl:0
    s_nop 1
    v_add_f32_dpp v10, v10, v10 row_shr:2 row_mask:0xf bank_mask:0xf bound_ctrl:0
    s_nop 1
    v_add_f32_dpp v10, v10, v10 row_shr:4 row_mask:0xf bank_mask:0xf bound_ctrl:0
    s_nop 1
    v_add_f32_dpp v10, v10, v10 row_shr:8 row_mask:0xf bank_mask:0xf bound_ctrl:0
    s_nop 1
    v_add_f32_dpp v10, v10, v10 row_bcast:15 row_mask:0xa bank_mask:0xf
    s_nop 1
    v_add_f32_dpp v10, v10, v10 row_bcast:31 row_mask:0xc bank_mask:0xf
    s_nop 1
    v_readlane_b32 s40, v10, 63
    s_nop 1
    v_mov_b32 v10, s40
    v_mul_f32 v10, -0.0015625, v10
    v_mov_b32 v11, v10
    v_pk_add_f32 v[12:13], v[60:61], v[10:11]
    v_pk_mul_f32 v[14:15], v[12:13], v[12:13]
    v_pk_add_f32 v[12:13], v[62:63], v[10:11]
    v_pk_fma_f32 v[14:15], v[12:13], v[12:13], v[14:15]
    v_pk_add_f32 v[12:13], v[64:65], v[10:11]
    v_pk_fma_f32 v[14:15], v[12:13], v[12:13], v[14:15]
    v_pk_add_f32 v[12:13], v[66:67], v[10:11]
    v_pk_fma_f32 v[14:15], v[12:13], v[12:13], v[14:15]
    v_pk_add_f32 v[12:13], v[68:69], v[10:11]
    v_pk_fma_f32 v[14:15], v[12:13], v[12:13], v[14:15]
    v_add_f32 v12, v14, v15
    s_nop 1
    v_add_f32_dpp v12, v12, v12 row_shr:1 row_mask:0xf bank_mask:0xf bound_ctrl:0
    s_nop 1
    v_add_f32_dpp v12, v12, v12 row_shr:2 row_mask:0xf bank_mask:0xf bound_ctrl:0
    s_nop 1
    v_add_f32_dpp v12, v12, v12 row_shr:4 row_mask:0xf bank_mask:0xf bound_ctrl:0
    s_nop 1
    v_add_f32_dpp v12, v12, v12 row_shr:8 row_mask:0xf bank_mask:0xf bound_ctrl:0
    s_nop 1
    v_add_f32_dpp v12, v12, v12 row_bcast:15 row_mask:0xa bank_mask:0xf
    s_nop 1
    v_add_f32_dpp v12, v12, v12 row_bcast:31 row_mask:0xc bank_mask:0xf
    s_nop 1
    v_readlane_b32 s41, v12, 63
    s_nop 1
    v_mov_b32 v11, s41
    v_mul_f32 v11, 0.0015625, v11
    v_cvt_pk_bf16_f32 v12, v10, v11
    v_lshlrev_b32 v10, 16, v12
    v_and_b32 v11, 0xffff0000, v12
    v_add_f32 v11, 0x3727c5ac, v11
    v_cvt_pk_bf16_f32 v12, v11, v11
    v_lshlrev_b32 v11, 16, v12
    v_and_b32 v11, 0xffff0000, v12
    v_sqrt_f32 v11, v11
    s_nop 0
    v_cvt_pk_bf16_f32 v12, v11, v11
    v_lshlrev_b32 v11, 16, v12
    v_and_b32 v11, 0xffff0000, v12
    v_rcp_f32 v12, v11
    v_mov_b32 v11, v10
    v_mov_b32 v13, v12
    v_pk_add_f32 v[100:101], v[60:61], v[10:11]
    v_cvt_pk_bf16_f32 v16, v100, v101
    v_lshlrev_b32 v100, 16, v16
    v_and_b32 v101, 0xffff0000, v16
    v_pk_mul_f32 v[100:101], v[100:101], v[12:13]
    v_cvt_pk_bf16_f32 v16, v100, v101
    v_lshlrev_b32 v100, 16, v16
    v_and_b32 v101, 0xffff0000, v16
    v_pk_add_f32 v[102:103], v[62:63], v[10:11]
    v_cvt_pk_bf16_f32 v16, v102, v103
    v_lshlrev_b32 v102, 16, v16
    v_and_b32 v103, 0xffff0000, v16
    v_pk_mul_f32 v[102:103], v[102:103], v[12:13]
    v_cvt_pk_bf16_f32 v16, v102, v103
    v_lshlrev_b32 v102, 16, v16
    v_and_b32 v103, 0xffff0000, v16
    v_pk_add_f32 v[104:105], v[64:65], v[10:11]
    v_cvt_pk_bf16_f32 v16, v104, v105
    v_lshlrev_b32 v104, 16, v16
    v_and_b32 v105, 0xffff0000, v16
    v_pk_mul_f32 v[104:105], v[104:105], v[12:13]
    v_cvt_pk_bf16_f32 v16, v104, v105
    v_lshlrev_b32 v104, 16, v16
    v_and_b32 v105, 0xffff0000, v16
    v_pk_add_f32 v[106:107], v[66:67], v[10:11]
    v_cvt_pk_bf16_f32 v16, v106, v107
    v_lshlrev_b32 v106, 16, v16
    v_and_b32 v107, 0xffff0000, v16
    v_pk_mul_f32 v[106:107], v[106:107], v[12:13]
    v_cvt_pk_bf16_f32 v16, v106, v107
    v_lshlrev_b32 v106, 16, v16
    v_and_b32 v107, 0xffff0000, v16
    v_pk_add_f32 v[108:109], v[68:69], v[10:11]
    v_cvt_pk_bf16_f32 v16, v108, v109
    v_lshlrev_b32 v108, 16, v16
    v_and_b32 v109, 0xffff0000, v16
    v_pk_mul_f32 v[108:109], v[108:109], v[12:13]
    v_cvt_pk_bf16_f32 v16, v108, v109
    v_lshlrev_b32 v108, 16, v16
    v_and_b32 v109, 0xffff0000, v16
    s_waitcnt vmcnt(0)
    v_lshlrev_b32 v80, 16, v40
    v_and_b32 v81, 0xffff0000, v40
    v_lshlrev_b32 v82, 16, v41
    v_and_b32 v83, 0xffff0000, v41
    v_lshlrev_b32 v84, 16, v42
    v_and_b32 v85, 0xffff0000, v42
    v_lshlrev_b32 v86, 16, v43
    v_and_b32 v87, 0xffff0000, v43
    v_lshlrev_b32 v88, 16, v44
    v_and_b32 v89, 0xffff0000, v44
    v_pk_mul_f32 v[100:101], v[100:101], v[80:81]
    v_cvt_pk_bf16_f32 v16, v100, v101
    v_lshlrev_b32 v100, 16, v16
    v_and_b32 v101, 0xffff0000, v16
    v_pk_add_f32 v[60:61], v[60:61], v[100:101]
    v_cvt_pk_bf16_f32 v120, v60, v61
    v_lshlrev_b32 v60, 16, v120
    v_and_b32 v61, 0xffff0000, v120
    v_pk_mul_f32 v[102:103], v[102:103], v[82:83]
    v_cvt_pk_bf16_f32 v16, v102, v103
    v_lshlrev_b32 v102, 16, v16
    v_and_b32 v103, 0xffff0000, v16
    v_pk_add_f32 v[62:63], v[62:63], v[102:103]
    v_cvt_pk_bf16_f32 v121, v62, v63
    v_lshlrev_b32 v62, 16, v121
    v_and_b32 v63, 0xffff0000, v121
    v_pk_mul_f32 v[104:105], v[104:105], v[84:85]
    v_cvt_pk_bf16_f32 v16, v104, v105
    v_lshlrev_b32 v104, 16, v16
    v_and_b32 v105, 0xffff0000, v16
    v_pk_add_f32 v[64:65], v[64:65], v[104:105]
    v_cvt_pk_bf16_f32 v122, v64, v65
    v_lshlrev_b32 v64, 16, v122
    v_and_b32 v65, 0xffff0000, v122
    v_pk_mul_f32 v[106:107], v[106:107], v[86:87]
    v_cvt_pk_bf16_f32 v16, v106, v107
    v_lshlrev_b32 v106, 16, v16
    v_and_b32 v107, 0xffff0000, v16
    v_pk_add_f32 v[66:67], v[66:67], v[106:107]
    v_cvt_pk_bf16_f32 v123, v66, v67
    v_lshlrev_b32 v66, 16, v123
    v_and_b32 v67, 0xffff0000, v123
    v_pk_mul_f32 v[108:109], v[108:109], v[88:89]
    v_cvt_pk_bf16_f32 v16, v108, v109
    v_lshlrev_b32 v108, 16, v16
    v_and_b32 v109, 0xffff0000, v16
    v_pk_add_f32 v[68:69], v[68:69], v[108:109]
    v_cvt_pk_bf16_f32 v124, v68, v69
    v_lshlrev_b32 v68, 16, v124
    v_and_b32 v69, 0xffff0000, v124
    buffer_store_dwordx4 v[120:123], v6, s[16:19], 0 offen
    buffer_store_dword v124, v8, s[16:19], 0 offen offset:1024
    v_pk_add_f32 v[10:11], v[60:61], v[62:63]
    v_pk_add_f32 v[10:11], v[10:11], v[64:65]
    v_pk_add_f32 v[10:11], v[10:11], v[66:67]
    v_pk_add_f32 v[10:11], v[10:11], v[68:69]
    v_add_f32 v10, v10, v11
    s_nop 1
    v_add_f32_dpp v10, v10, v10 row_shr:1 row_mask:0xf bank_mask:0xf bound_ctrl:0
    s_nop 1
    v_add_f32_dpp v10, v10, v10 row_shr:2 row_mask:0xf bank_mask:0xf bound_ctrl:0
    s_nop 1
    v_add_f32_dpp v10, v10, v10 row_shr:4 row_mask:0xf bank_mask:0xf bound_ctrl:0
    s_nop 1
    v_add_f32_dpp v10, v10, v10 row_shr:8 row_mask:0xf bank_mask:0xf bound_ctrl:0
    s_nop 1
    v_add_f32_dpp v10, v10, v10 row_bcast:15 row_mask:0xa bank_mask:0xf
    s_nop 1
    v_add_f32_dpp v10, v10, v10 row_bcast:31 row_mask:0xc bank_mask:0xf
    s_nop 1
    v_readlane_b32 s40, v10, 63
    s_nop 1
    v_mov_b32 v10, s40
    v_mul_f32 v10, -0.0015625, v10
    v_mov_b32 v11, v10
    v_pk_add_f32 v[12:13], v[60:61], v[10:11]
    v_pk_mul_f32 v[14:15], v[12:13], v[12:13]
    v_pk_add_f32 v[12:13], v[62:63], v[10:11]
    v_pk_fma_f32 v[14:15], v[12:13], v[12:13], v[14:15]
    v_pk_add_f32 v[12:13], v[64:65], v[10:11]
    v_pk_fma_f32 v[14:15], v[12:13], v[12:13], v[14:15]
    v_pk_add_f32 v[12:13], v[66:67], v[10:11]
    v_pk_fma_f32 v[14:15], v[12:13], v[12:13], v[14:15]
    v_pk_add_f32 v[12:13], v[68:69], v[10:11]
    v_pk_fma_f32 v[14:15], v[12:13], v[12:13], v[14:15]
    v_add_f32 v12, v14, v15
    s_nop 1
    v_add_f32_dpp v12, v12, v12 row_shr:1 row_mask:0xf bank_mask:0xf bound_ctrl:0
    s_nop 1
    v_add_f32_dpp v12, v12, v12 row_shr:2 row_mask:0xf bank_mask:0xf bound_ctrl:0
    s_nop 1
    v_add_f32_dpp v12, v12, v12 row_shr:4 row_mask:0xf bank_mask:0xf bound_ctrl:0
    s_nop 1
    v_add_f32_dpp v12, v12, v12 row_shr:8 row_mask:0xf bank_mask:0xf bound_ctrl:0
    s_nop 1
    v_add_f32_dpp v12, v12, v12 row_bcast:15 row_mask:0xa bank_mask:0xf
    s_nop 1
    v_add_f32_dpp v12, v12, v12 row_bcast:31 row_mask:0xc bank_mask:0xf
    s_nop 1
    v_readlane_b32 s41, v12, 63
    s_nop 1
    v_mov_b32 v11, s41
    v_mul_f32 v11, 0.0015625, v11
    v_cvt_pk_bf16_f32 v12, v10, v11
    v_lshlrev_b32 v10, 16, v12
    v_and_b32 v11, 0xffff0000, v12
    v_add_f32 v11, 0x3727c5ac, v11
    v_cvt_pk_bf16_f32 v12, v11, v11
    v_lshlrev_b32 v11, 16, v12
    v_and_b32 v11, 0xffff0000, v12
    v_sqrt_f32 v11, v11
    s_nop 0
    v_cvt_pk_bf16_f32 v12, v11, v11
    v_lshlrev_b32 v11, 16, v12
    v_and_b32 v11, 0xffff0000, v12
    v_rcp_f32 v12, v11
    v_mov_b32 v11, v10
    v_mov_b32 v13, v12
    v_pk_add_f32 v[100:101], v[60:61], v[10:11]
    v_cvt_pk_bf16_f32 v16, v100, v101
    v_lshlrev_b32 v100, 16, v16
    v_and_b32 v101, 0xffff0000, v16
    v_pk_mul_f32 v[100:101], v[100:101], v[12:13]
    v_cvt_pk_bf16_f32 v16, v100, v101
    v_lshlrev_b32 v100, 16, v16
    v_and_b32 v101, 0xffff0000, v16
    v_pk_add_f32 v[102:103], v[62:63], v[10:11]
    v_cvt_pk_bf16_f32 v16, v102, v103
    v_lshlrev_b32 v102, 16, v16
    v_and_b32 v103, 0xffff0000, v16
    v_pk_mul_f32 v[102:103], v[102:103], v[12:13]
    v_cvt_pk_bf16_f32 v16, v102, v103
    v_lshlrev_b32 v102, 16, v16
    v_and_b32 v103, 0xffff0000, v16
    v_pk_add_f32 v[104:105], v[64:65], v[10:11]
    v_cvt_pk_bf16_f32 v16, v104, v105
    v_lshlrev_b32 v104, 16, v16
    v_and_b32 v105, 0xffff0000, v16
    v_pk_mul_f32 v[104:105], v[104:105], v[12:13]
    v_cvt_pk_bf16_f32 v16, v104, v105
    v_lshlrev_b32 v104, 16, v16
    v_and_b32 v105, 0xffff0000, v16
    v_pk_add_f32 v[106:107], v[66:67], v[10:11]
    v_cvt_pk_bf16_f32 v16, v106, v107
    v_lshlrev_b32 v106, 16, v16
    v_and_b32 v107, 0xffff0000, v16
    v_pk_mul_f32 v[106:107], v[106:107], v[12:13]
    v_cvt_pk_bf16_f32 v16, v106, v107
    v_lshlrev_b32 v106, 16, v16
    v_and_b32 v107, 0xffff0000, v16
    v_pk_add_f32 v[108:109], v[68:69], v[10:11]
    v_cvt_pk_bf16_f32 v16, v108, v109
    v_lshlrev_b32 v108, 16, v16
    v_and_b32 v109, 0xffff0000, v16
    v_pk_mul_f32 v[108:109], v[108:109], v[12:13]
    v_cvt_pk_bf16_f32 v16, v108, v109
    v_lshlrev_b32 v108, 16, v16
    v_and_b32 v109, 0xffff0000, v16
    v_cvt_pk_bf16_f32 v128, v100, v101
    v_cvt_pk_bf16_f32 v129, v102, v103
    v_cvt_pk_bf16_f32 v130, v104, v105
    v_cvt_pk_bf16_f32 v131, v106, v107
    v_cvt_pk_bf16_f32 v132, v108, v109
    v_lshlrev_b32 v7, 15, v1
    v_lshl_add_u32 v7, v5, 4, v7
    buffer_store_dwordx4 v[128:131], v7, s[20:23], 0 offen
    v_lshrrev_b32 v7, 2, v1
    v_lshlrev_b32 v7, 15, v7
    v_lshl_add_u32 v7, v5, 4, v7
    v_and_b32 v9, 3, v1
    v_lshl_add_u32 v7, v9, 2, v7
    v_add_u32 v7, 0x200000, v7
    buffer_store_dword v132, v7, s[20:23], 0 offen
L_lnx1_kernel_end:
    s_endpgm
.globl gemm3_1_kernel
.p2align 8
.type gemm3_1_kernel,@function
gemm3_1_kernel:
    s_cmp_ge_u32 s2, 256
    s_cbranch_scc1 L_gemm3_1_kernel_end
    s_load_dwordx2 s[4:5], s[0:1], 104
    s_load_dwordx4 s[28:31], s[0:1], 64
    s_load_dwordx2 s[32:33], s[0:1], 88
    s_and_b32 s6, s2, 7
    s_lshr_b32 s7, s2, 3
    s_mul_i32 s22, s6, 4
    s_lshr_b32 s3, s7, 3
    s_add_u32 s22, s22, s3
    s_and_b32 s23, s7, 7
    v_and_b32 v1, 63, v0
    v_and_b32 v2, 15, v0
    v_bfe_u32 v3, v0, 4, 2
    v_lshrrev_b32 v4, 6, v0
    s_nop 0
    v_readfirstlane_b32 s21, v4
    s_mul_i32 s34, s22, 64
    s_mul_i32 s35, s23, 80
    s_cmp_lt_u32 s21, 4
    s_cbranch_scc1 L_gemm3_1_kernel_comp
    s_sub_u32 s21, s21, 4
    s_setprio 3
    s_mul_i32 s3, s21, 128
    s_add_u32 s3, s3, 0
    v_add_u32 v5, s3, v1
    v_lshrrev_b32 v6, 6, v5
    v_and_b32 v5, 63, v5
    v_mul_u32_u24 v6, 2048, v6
    v_add3_u32 v5, v5, v6, s34
    v_lshlrev_b32 v10, 4, v5
    s_mul_i32 s3, s21, 128
    s_add_u32 s3, s3, 64
    v_add_u32 v5, s3, v1
    v_lshrrev_b32 v6, 6, v5
    v_and_b32 v5, 63, v5
    v_mul_u32_u24 v6, 2048, v6
    v_add3_u32 v5, v5, v6, s34
    v_lshlrev_b32 v11, 4, v5
    s_lshl_b32 s3, s21, 6
    s_add_u32 s3, s3, 0
    v_add_u32 v5, s3, v1
    v_mul_u32_u24 v6, 205, v5
    v_lshrrev_b32 v6, 14, v6
    v_mul_u32_u24 v7, 80, v6
    v_sub_u32 v7, v5, v7
    v_mul_u32_u24 v6, 640, v6
    v_add3_u32 v7, v7, v6, s35
    v_lshlrev_b32 v14, 4, v7
    s_lshl_b32 s3, s21, 6
    s_add_u32 s3, s3, 256
    v_add_u32 v5, s3, v1
    v_mul_u32_u24 v6, 205, v5
    v_lshrrev_b32 v6, 14, v6
    v_mul_u32_u24 v7, 80, v6
    v_sub_u32 v7, v5, v7
    v_mul_u32_u24 v6, 640, v6
    v_add3_u32 v7, v7, v6, s35
    v_lshlrev_b32 v15, 4, v7
    s_lshl_b32 s3, s21, 6
    s_add_u32 s3, s3, 512
    v_add_u32 v5, s3, v1
    v_mul_u32_u24 v6, 205, v5
    v_lshrrev_b32 v6, 14, v6
    v_mul_u32_u24 v7, 80, v6
    v_sub_u32 v7, v5, v7
    v_mul_u32_u24 v6, 640, v6
    v_add3_u32 v7, v7, v6, s35
    v_lshlrev_b32 v16, 4, v7
    s_mul_i32 s24, s21, 2048
    s_lshl_b32 s25, s21, 10
    s_add_u32 s25, s25, 8192
    s_mov_b32 s16, 0
    s_mov_b32 s17, 0
    s_mov_b32 s18, 0
    s_waitcnt lgkmcnt(0)
    s_add_u32 s8, s4, 37748736
    s_addc_u32 s9, s5, 0
    s_mov_b32 s10, 3145728
    s_mov_b32 s11, 0x00020000
    s_add_u32 s12, s4, 12582912
    s_addc_u32 s13, s5, 0
    s_mov_b32 s14, 983040
    s_mov_b32 s15, 0x00020000
    s_cmp_lt_u32 s21, 2
    s_cbranch_scc0 L_gemm3_1_kernel_ld2
    s_add_u32 s26, s18, s24
    s_add_u32 s27, s18, s25
    s_add_u32 m0, s26, 0
    s_nop 0
    buffer_load_dwordx4 v10, s[8:11], s16 offen lds
    s_add_u32 m0, s26, 1024
    s_nop 0
    buffer_load_dwordx4 v11, s[8:11], s16 offen lds
    s_add_u32 m0, s27, 0
    s_nop 0
    buffer_load_dwordx4 v14, s[12:15], s17 offen lds
    s_add_u32 m0, s27, 4096
    s_nop 0
    buffer_load_dwordx4 v15, s[12:15], s17 offen lds
    s_add_u32 m0, s27, 8192
    s_nop 0
    buffer_load_dwordx4 v16, s[12:15], s17 offen lds
    s_add_u32 s16, s16, 262144
    s_add_u32 s17, s17, 81920
    s_add_u32 s18, s18, 20480
    s_cmp_eq_u32 s18, 143360
    s_cselect_b32 s18, 0, s18
    s_add_u32 s26, s18, s24
    s_add_u32 s27, s18, s25
    s_add_u32 m0, s26, 0
    s_nop 0
    buffer_load_dwordx4 v10, s[8:11], s16 offen lds
    s_add_u32 m0, s26, 1024
    s_nop 0
    buffer_load_dwordx4 v11, s[8:11], s16 offen lds
    s_add_u32 m0, s27, 0
    s_nop 0
    buffer_load_dwordx4 v14, s[12:15], s17 offen lds
    s_add_u32 m0, s27, 4096
    s_nop 0
    buffer_load_dwordx4 v15, s[12:15], s17 offen lds
    s_add_u32 m0, s27, 8192
    s_nop 0
    buffer_load_dwordx4 v16, s[12:15], s17 offen lds
    s_add_u32 s16, s16, 262144
    s_add_u32 s17, s17, 81920
    s_add_u32 s18, s18, 20480
    s_cmp_eq_u32 s18, 143360
    s_cselect_b32 s18, 0, s18
    s_add_u32 s26, s18, s24
    s_add_u32 s27, s18, s25
    s_add_u32 m0, s26, 0
    s_nop 0
    buffer_load_dwordx4 v10, s[8:11], s16 offen lds
    s_add_u32 m0, s26, 1024
    s_nop 0
    buffer_load_dwordx4 v11, s[8:11], s16 offen lds
    s_add_u32 m0, s27, 0
    s_nop 0
    buffer_load_dwordx4 v14, s[12:15], s17 offen lds
    s_add_u32 m0, s27, 4096
    s_nop 0
    buffer_load_dwordx4 v15, s[12:15], s17 offen lds
    s_add_u32 m0, s27, 8192
    s_nop 0
    buffer_load_dwordx4 v16, s[12:15], s17 offen lds
    s_add_u32 s16, s16, 262144
    s_add_u32 s17, s17, 81920
    s_add_u32 s18, s18, 20480
    s_cmp_eq_u32 s18, 143360
    s_cselect_b32 s18, 0, s18
    s_add_u32 s26, s18, s24
    s_add_u32 s27, s18, s25
    s_add_u32 m0, s26, 0
    s_nop 0
    buffer_load_dwordx4 v10, s[8:11], s16 offen lds
    s_add_u32 m0, s26, 1024
    s_nop 0
    buffer_load_dwordx4 v11, s[8:11], s16 offen lds
    s_add_u32 m0, s27, 0
    s_nop 0
    buffer_load_dwordx4 v14, s[12:15], s17 offen lds
    s_add_u32 m0, s27, 4096
    s_nop 0
    buffer_load_dwordx4 v15, s[12:15], s17 offen lds
    s_add_u32 m0, s27, 8192
    s_nop 0
    buffer_load_dwordx4 v16, s[12:15], s17 offen lds
    s_add_u32 s16, s16, 262144
    s_add_u32 s17, s17, 81920
    s_add_u32 s18, s18, 20480
    s_cmp_eq_u32 s18, 143360
    s_cselect_b32 s18, 0, s18
    s_waitcnt vmcnt(10)
    s_barrier
    s_add_u32 s26, s18, s24
    s_add_u32 s27, s18, s25
    s_add_u32 m0, s26, 0
    s_nop 0
    buffer_load_dwordx4 v10, s[8:11], s16 offen lds
    s_add_u32 m0, s26, 1024
    s_nop 0
    buffer_load_dwordx4 v11, s[8:11], s16 offen lds
    s_add_u32 m0, s27, 0
    s_nop 0
    buffer_load_dwordx4 v14, s[12:15], s17 offen lds
    s_add_u32 m0, s27, 4096
    s_nop 0
    buffer_load_dwordx4 v15, s[12:15], s17 offen lds
    s_add_u32 m0, s27, 8192
    s_nop 0
    buffer_load_dwordx4 v16, s[12:15], s17 offen lds
    s_add_u32 s16, s16, 262144
    s_add_u32 s17, s17, 81920
    s_add_u32 s18, s18, 20480
    s_cmp_eq_u32 s18, 143360
    s_cselect_b32 s18, 0, s18
    s_add_u32 s26, s18, s24
    s_add_u32 s27, s18, s25
    s_add_u32 m0, s26, 0
    s_nop 0
    buffer_load_dwordx4 v10, s[8:11], s16 offen lds
    s_add_u32 m0, s26, 1024
    s_nop 0
    buffer_load_dwordx4 v11, s[8:11], s16 offen lds
    s_add_u32 m0, s27, 0
    s_nop 0
    buffer_load_dwordx4 v14, s[12:15], s17 offen lds
    s_add_u32 m0, s27, 4096
    s_nop 0
    buffer_load_dwordx4 v15, s[12:15], s17 offen lds
    s_add_u32 m0, s27, 8192
    s_nop 0
    buffer_load_dwordx4 v16, s[12:15], s17 offen lds
    s_add_u32 s16, s16, 262144
    s_add_u32 s17, s17, 81920
    s_add_u32 s18, s18, 20480
    s_cmp_eq_u32 s18, 143360
    s_cselect_b32 s18, 0, s18
    s_waitcnt vmcnt(15)
    s_barrier
    s_add_u32 s26, s18, s24
    s_add_u32 s27, s18, s25
    s_add_u32 m0, s26, 0
    s_nop 0
    buffer_load_dwordx4 v10, s[8:11], s16 offen lds
    s_add_u32 m0, s26, 1024
    s_nop 0
    buffer_load_dwordx4 v11, s[8:11], s16 offen lds
    s_add_u32 m0, s27, 0
    s_nop 0
    buffer_load_dwordx4 v14, s[12:15], s17 offen lds
    s_add_u32 m0, s27, 4096
    s_nop 0
    buffer_load_dwordx4 v15, s[12:15], s17 offen lds
    s_add_u32 m0, s27, 8192
    s_nop 0
    buffer_load_dwordx4 v16, s[12:15], s17 offen lds
    s_add_u32 s16, s16, 262144
    s_add_u32 s17, s17, 81920
    s_add_u32 s18, s18, 20480
    s_cmp_eq_u32 s18, 143360
    s_cselect_b32 s18, 0, s18
    s_add_u32 s26, s18, s24
    s_add_u32 s27, s18, s25
    s_add_u32 m0, s26, 0
    s_nop 0
    buffer_load_dwordx4 v10, s[8:11], s16 offen lds
    s_add_u32 m0, s26, 1024
    s_nop 0
    buffer_load_dwordx4 v11, s[8:11], s16 offen lds
    s_add_u32 m0, s27, 0
    s_nop 0
    buffer_load_dwordx4 v14, s[12:15], s17 offen lds
    s_add_u32 m0, s27, 4096
    s_nop 0
    buffer_load_dwordx4 v15, s[12:15], s17 offen lds
    s_add_u32 m0, s27, 8192
    s_nop 0
    buffer_load_dwordx4 v16, s[12:15], s17 offen lds
    s_add_u32 s16, s16, 262144
    s_add_u32 s17, s17, 81920
    s_add_u32 s18, s18, 20480
    s_cmp_eq_u32 s18, 143360
    s_cselect_b32 s18, 0, s18
    s_waitcnt vmcnt(20)
    s_barrier
    s_add_u32 s26, s18, s24
    s_add_u32 s27, s18, s25
    s_add_u32 m0, s26, 0
    s_nop 0
    buffer_load_dwordx4 v10, s[8:11], s16 offen lds
    s_add_u32 m0, s26, 1024
    s_nop 0
    buffer_load_dwordx4 v11, s[8:11], s16 offen lds
    s_add_u32 m0, s27, 0
    s_nop 0
    buffer_load_dwordx4 v14, s[12:15], s17 offen lds
    s_add_u32 m0, s27, 4096
    s_nop 0
    buffer_load_dwordx4 v15, s[12:15], s17 offen lds
    s_add_u32 m0, s27, 8192
    s_nop 0
    buffer_load_dwordx4 v16, s[12:15], s17 offen lds
    s_add_u32 s16, s16, 262144
    s_add_u32 s17, s17, 81920
    s_add_u32 s18, s18, 20480
    s_cmp_eq_u32 s18, 143360
    s_cselect_b32 s18, 0, s18
    s_add_u32 s26, s18, s24
    s_add_u32 s27, s18, s25
    s_add_u32 m0, s26, 0
    s_nop 0
    buffer_load_dwordx4 v10, s[8:11], s16 offen lds
    s_add_u32 m0, s26, 1024
    s_nop 0
    buffer_load_dwordx4 v11, s[8:11], s16 offen lds
    s_add_u32 m0, s27, 0
    s_nop 0
    buffer_load_dwordx4 v14, s[12:15], s17 offen lds
    s_add_u32 m0, s27, 4096
    s_nop 0
    buffer_load_dwordx4 v15, s[12:15], s17 offen lds
    s_add_u32 m0, s27, 8192
    s_nop 0
    buffer_load_dwordx4 v16, s[12:15], s17 offen lds
    s_add_u32 s16, s16, 262144
    s_add_u32 s17, s17, 81920
    s_add_u32 s18, s18, 20480
    s_cmp_eq_u32 s18, 143360
    s_cselect_b32 s18, 0, s18
    s_mov_b32 s20, 2
L_gemm3_1_kernel_lloopa:
    s_waitcnt vmcnt(25)
    s_barrier
    s_add_u32 s26, s18, s24
    s_add_u32 s27, s18, s25
    s_add_u32 m0, s26, 0
    s_nop 0
    buffer_load_dwordx4 v10, s[8:11], s16 offen lds
    s_add_u32 m0, s26, 1024
    s_nop 0
    buffer_load_dwordx4 v11, s[8:11], s16 offen lds
    s_add_u32 m0, s27, 0
    s_nop 0
    buffer_load_dwordx4 v14, s[12:15], s17 offen lds
    s_add_u32 m0, s27, 4096
    s_nop 0
    buffer_load_dwordx4 v15, s[12:15], s17 offen lds
    s_add_u32 m0, s27, 8192
    s_nop 0
    buffer_load_dwordx4 v16, s[12:15], s17 offen lds
    s_add_u32 s16, s16, 262144
    s_add_u32 s17, s17, 81920
    s_add_u32 s18, s18, 20480
    s_cmp_eq_u32 s18, 143360
    s_cselect_b32 s18, 0, s18
    s_sub_u32 s20, s20, 1
    s_cmp_lg_u32 s20, 0
    s_cbranch_scc1 L_gemm3_1_kernel_lloopa
    s_waitcnt vmcnt(25)
    s_barrier
    s_waitcnt vmcnt(20)
    s_barrier
    s_waitcnt vmcnt(15)
    s_barrier
    s_waitcnt vmcnt(10)
    s_barrier
    s_waitcnt vmcnt(5)
    s_barrier
    s_waitcnt vmcnt(0)
    s_barrier
    s_waitcnt vmcnt(0)
    s_barrier
    s_waitcnt vmcnt(0)
    s_barrier
    s_branch L_gemm3_1_kernel_end
L_gemm3_1_kernel_ld2:
    s_add_u32 s26, s18, s24
    s_add_u32 s27, s18, s25
    s_add_u32 m0, s26, 0
    s_nop 0
    buffer_load_dwordx4 v10, s[8:11], s16 offen lds
    s_add_u32 m0, s26, 1024
    s_nop 0
    buffer_load_dwordx4 v11, s[8:11], s16 offen lds
    s_add_u32 m0, s27, 0
    s_nop 0
    buffer_load_dwordx4 v14, s[12:15], s17 offen lds
    s_add_u32 m0, s27, 4096
    s_nop 0
    buffer_load_dwordx4 v15, s[12:15], s17 offen lds
    s_add_u32 s16, s16, 262144
    s_add_u32 s17, s17, 81920
    s_add_u32 s18, s18, 20480
    s_cmp_eq_u32 s18, 143360
    s_cselect_b32 s18, 0, s18
    s_add_u32 s26, s18, s24
    s_add_u32 s27, s18, s25
    s_add_u32 m0, s26, 0
    s_nop 0
    buffer_load_dwordx4 v10, s[8:11], s16 offen lds
    s_add_u32 m0, s26, 1024
    s_nop 0
    buffer_load_dwordx4 v11, s[8:11], s16 offen lds
    s_add_u32 m0, s27, 0
    s_nop 0
    buffer_load_dwordx4 v14, s[12:15], s17 offen lds
    s_add_u32 m0, s27, 4096
    s_nop 0
    buffer_load_dwordx4 v15, s[12:15], s17 offen lds
    s_add_u32 s16, s16, 262144
    s_add_u32 s17, s17, 81920
    s_add_u32 s18, s18, 20480
    s_cmp_eq_u32 s18, 143360
    s_cselect_b32 s18, 0, s18
    s_add_u32 s26, s18, s24
    s_add_u32 s27, s18, s25
    s_add_u32 m0, s26, 0
    s_nop 0
    buffer_load_dwordx4 v10, s[8:11], s16 offen lds
    s_add_u32 m0, s26, 1024
    s_nop 0
    buffer_load_dwordx4 v11, s[8:11], s16 offen lds
    s_add_u32 m0, s27, 0
    s_nop 0
    buffer_load_dwordx4 v14, s[12:15], s17 offen lds
    s_add_u32 m0, s27, 4096
    s_nop 0
    buffer_load_dwordx4 v15, s[12:15], s17 offen lds
    s_add_u32 s16, s16, 262144
    s_add_u32 s17, s17, 81920
    s_add_u32 s18, s18, 20480
    s_cmp_eq_u32 s18, 143360
    s_cselect_b32 s18, 0, s18
    s_add_u32 s26, s18, s24
    s_add_u32 s27, s18, s25
    s_add_u32 m0, s26, 0
    s_nop 0
    buffer_load_dwordx4 v10, s[8:11], s16 offen lds
    s_add_u32 m0, s26, 1024
    s_nop 0
    buffer_load_dwordx4 v11, s[8:11], s16 offen lds
    s_add_u32 m0, s27, 0
    s_nop 0
    buffer_load_dwordx4 v14, s[12:15], s17 offen lds
    s_add_u32 m0, s27, 4096
    s_nop 0
    buffer_load_dwordx4 v15, s[12:15], s17 offen lds
    s_add_u32 s16, s16, 262144
    s_add_u32 s17, s17, 81920
    s_add_u32 s18, s18, 20480
    s_cmp_eq_u32 s18, 143360
    s_cselect_b32 s18, 0, s18
    s_waitcnt vmcnt(8)
    s_barrier
    s_add_u32 s26, s18, s24
    s_add_u32 s27, s18, s25
    s_add_u32 m0, s26, 0
    s_nop 0
    buffer_load_dwordx4 v10, s[8:11], s16 offen lds
    s_add_u32 m0, s26, 1024
    s_nop 0
    buffer_load_dwordx4 v11, s[8:11], s16 offen lds
    s_add_u32 m0, s27, 0
    s_nop 0
    buffer_load_dwordx4 v14, s[12:15], s17 offen lds
    s_add_u32 m0, s27, 4096
    s_nop 0
    buffer_load_dwordx4 v15, s[12:15], s17 offen lds
    s_add_u32 s16, s16, 262144
    s_add_u32 s17, s17, 81920
    s_add_u32 s18, s18, 20480
    s_cmp_eq_u32 s18, 143360
    s_cselect_b32 s18, 0, s18
    s_add_u32 s26, s18, s24
    s_add_u32 s27, s18, s25
    s_add_u32 m0, s26, 0
    s_nop 0
    buffer_load_dwordx4 v10, s[8:11], s16 offen lds
    s_add_u32 m0, s26, 1024
    s_nop 0
    buffer_load_dwordx4 v11, s[8:11], s16 offen lds
    s_add_u32 m0, s27, 0
    s_nop 0
    buffer_load_dwordx4 v14, s[12:15], s17 offen lds
    s_add_u32 m0, s27, 4096
    s_nop 0
    buffer_load_dwordx4 v15, s[12:15], s17 offen lds
    s_add_u32 s16, s16, 262144
    s_add_u32 s17, s17, 81920
    s_add_u32 s18, s18, 20480
    s_cmp_eq_u32 s18, 143360
    s_cselect_b32 s18, 0, s18
    s_waitcnt vmcnt(12)
    s_barrier
    s_add_u32 s26, s18, s24
    s_add_u32 s27, s18, s25
    s_add_u32 m0, s26, 0
    s_nop 0
    buffer_load_dwordx4 v10, s[8:11], s16 offen lds
    s_add_u32 m0, s26, 1024
    s_nop 0
    buffer_load_dwordx4 v11, s[8:11], s16 offen lds
    s_add_u32 m0, s27, 0
    s_nop 0
    buffer_load_dwordx4 v14, s[12:15], s17 offen lds
    s_add_u32 m0, s27, 4096
    s_nop 0
    buffer_load_dwordx4 v15, s[12:15], s17 offen lds
    s_add_u32 s16, s16, 262144
    s_add_u32 s17, s17, 81920
    s_add_u32 s18, s18, 20480
    s_cmp_eq_u32 s18, 143360
    s_cselect_b32 s18, 0, s18
    s_add_u32 s26, s18, s24
    s_add_u32 s27, s18, s25
    s_add_u32 m0, s26, 0
    s_nop 0
    buffer_load_dwordx4 v10, s[8:11], s16 offen lds
    s_add_u32 m0, s26, 1024
    s_nop 0
    buffer_load_dwordx4 v11, s[8:11], s16 offen lds
    s_add_u32 m0, s27, 0
    s_nop 0
    buffer_load_dwordx4 v14, s[12:15], s17 offen lds
    s_add_u32 m0, s27, 4096
    s_nop 0
    buffer_load_dwordx4 v15, s[12:15], s17 offen lds
    s_add_u32 s16, s16, 262144
    s_add_u32 s17, s17, 81920
    s_add_u32 s18, s18, 20480
    s_cmp_eq_u32 s18, 143360
    s_cselect_b32 s18, 0, s18
    s_waitcnt vmcnt(16)
    s_barrier
    s_add_u32 s26, s18, s24
    s_add_u32 s27, s18, s25
    s_add_u32 m0, s26, 0
    s_nop 0
    buffer_load_dwordx4 v10, s[8:11], s16 offen lds
    s_add_u32 m0, s26, 1024
    s_nop 0
    buffer_load_dwordx4 v11, s[8:11], s16 offen lds
    s_add_u32 m0, s27, 0
    s_nop 0
    buffer_load_dwordx4 v14, s[12:15], s17 offen lds
    s_add_u32 m0, s27, 4096
    s_nop 0
    buffer_load_dwordx4 v15, s[12:15], s17 offen lds
    s_add_u32 s16, s16, 262144
    s_add_u32 s17, s17, 81920
    s_add_u32 s18, s18, 20480
    s_cmp_eq_u32 s18, 143360
    s_cselect_b32 s18, 0, s18
    s_add_u32 s26, s18, s24
    s_add_u32 s27, s18, s25
    s_add_u32 m0, s26, 0
    s_nop 0
    buffer_load_dwordx4 v10, s[8:11], s16 offen lds
    s_add_u32 m0, s26, 1024
    s_nop 0
    buffer_load_dwordx4 v11, s[8:11], s16 offen lds
    s_add_u32 m0, s27, 0
    s_nop 0
    buffer_load_dwordx4 v14, s[12:15], s17 offen lds
    s_add_u32 m0, s27, 4096
    s_nop 0
    buffer_load_dwordx4 v15, s[12:15], s17 offen lds
    s_add_u32 s16, s16, 262144
    s_add_u32 s17, s17, 81920
    s_add_u32 s18, s18, 20480
    s_cmp_eq_u32 s18, 143360
    s_cselect_b32 s18, 0, s18
    s_mov_b32 s20, 2
L_gemm3_1_kernel_lloopb:
    s_waitcnt vmcnt(20)
    s_barrier
    s_add_u32 s26, s18, s24
    s_add_u32 s27, s18, s25
    s_add_u32 m0, s26, 0
    s_nop 0
    buffer_load_dwordx4 v10, s[8:11], s16 offen lds
    s_add_u32 m0, s26, 1024
    s_nop 0
    buffer_load_dwordx4 v11, s[8:11], s16 offen lds
    s_add_u32 m0, s27, 0
    s_nop 0
    buffer_load_dwordx4 v14, s[12:15], s17 offen lds
    s_add_u32 m0, s27, 4096
    s_nop 0
    buffer_load_dwordx4 v15, s[12:15], s17 offen lds
    s_add_u32 s16, s16, 262144
    s_add_u32 s17, s17, 81920
    s_add_u32 s18, s18, 20480
    s_cmp_eq_u32 s18, 143360
    s_cselect_b32 s18, 0, s18
    s_sub_u32 s20, s20, 1
    s_cmp_lg_u32 s20, 0
    s_cbranch_scc1 L_gemm3_1_kernel_lloopb
    s_waitcnt vmcnt(20)
    s_barrier
    s_waitcnt vmcnt(16)
    s_barrier
    s_waitcnt vmcnt(12)
    s_barrier
    s_waitcnt vmcnt(8)
    s_barrier
    s_waitcnt vmcnt(4)
    s_barrier
    s_waitcnt vmcnt(0)
    s_barrier
    s_waitcnt vmcnt(0)
    s_barrier
    s_waitcnt vmcnt(0)
    s_barrier
    s_branch L_gemm3_1_kernel_end
L_gemm3_1_kernel_comp:
    s_mov_b32 s36, s21
    s_mov_b32 s37, 0
    s_mul_i32 s36, s36, 16
    s_mul_i32 s37, s37, 80
    v_mul_u32_u24 v5, 64, v3
    v_add3_u32 v5, v5, v2, s36
    v_lshlrev_b32 v18, 4, v5
    v_mul_u32_u24 v5, 80, v3
    v_add3_u32 v5, v5, v2, s37
    v_lshlrev_b32 v5, 4, v5
    v_add_u32 v20, 8192, v5
    v_mov_b32 v120, 0
    v_mov_b32 v121, 0
    v_mov_b32 v122, 0
    v_mov_b32 v123, 0
    v_mov_b32 v124, 0
    v_mov_b32 v125, 0
    v_mov_b32 v126, 0
    v_mov_b32 v127, 0
    v_mov_b32 v128, 0
    v_mov_b32 v129, 0
    v_mov_b32 v130, 0
    v_mov_b32 v131, 0
    v_mov_b32 v132, 0
    v_mov_b32 v133, 0
    v_mov_b32 v134, 0
    v_mov_b32 v135, 0
    v_mov_b32 v136, 0
    v_mov_b32 v137, 0
    v_mov_b32 v138, 0
    v_mov_b32 v139, 0
    s_waitcnt lgkmcnt(0)
    s_add_u32 s40, s4, 16777216
    s_addc_u32 s41, s5, 0
    s_mov_b32 s42, 2621440
    s_mov_b32 s43, 0x00020000
    s_add_u32 s3, s35, s37
    s_add_u32 s6, s34, s36
    v_add_u32 v8, s6, v2
    v_mul_u32_u24 v5, 1280, v8
    v_lshl_add_u32 v6, v3, 2, s3
    v_lshl_add_u32 v9, v6, 1, v5
    buffer_load_dwordx2 v[140:141], v9, s[40:43], 0 offen offset:0
    buffer_load_dwordx2 v[142:143], v9, s[40:43], 0 offen offset:32
    buffer_load_dwordx2 v[144:145], v9, s[40:43], 0 offen offset:64
    buffer_load_dwordx2 v[146:147], v9, s[40:43], 0 offen offset:96
    buffer_load_dwordx2 v[148:149], v9, s[40:43], 0 offen offset:128
    s_mov_b32 s19, 0
    s_mov_b32 s20, 6
    v_add_u32 v21, s19, v18
    v_add_u32 v23, s19, v20
    s_mov_b32 s82, 0
    s_barrier
    ds_read_b128 v[24:27], v21 offset:0
    ds_read_b128 v[28:31], v23 offset:0
    ds_read_b128 v[32:35], v23 offset:256
    ds_read_b128 v[36:39], v23 offset:512
    ds_read_b128 v[40:43], v23 offset:768
    ds_read_b128 v[44:47], v23 offset:1024
    ds_read_b128 v[48:51], v21 offset:4096
    ds_read_b128 v[52:55], v23 offset:5120
    ds_read_b128 v[56:59], v23 offset:5376
    ds_read_b128 v[60:63], v23 offset:5632
    ds_read_b128 v[64:67], v23 offset:5888
    ds_read_b128 v[68:71], v23 offset:6144
    s_add_u32 s19, s19, 20480
    s_cmp_eq_u32 s19, 143360
    s_cselect_b32 s19, 0, s19
    v_add_u32 v21, s19, v18
    v_add_u32 v23, s19, v20
    s_waitcnt lgkmcnt(0)
L_gemm3_1_kernel_loop:
    v_mfma_f32_16x16x32_bf16 v[120:123], v[28:31], v[24:27], v[120:123]
    ds_read_b128 v[72:75], v21 offset:0
    v_mfma_f32_16x16x32_bf16 v[124:127], v[32:35], v[24:27], v[124:127]
    ds_read_b128 v[76:79], v23 offset:0
    v_mfma_f32_16x16x32_bf16 v[128:131], v[36:39], v[24:27], v[128:131]
    ds_read_b128 v[80:83], v23 offset:256
    v_mfma_f32_16x16x32_bf16 v[132:135], v[40:43], v[24:27], v[132:135]
    ds_read_b128 v[84:87], v23 offset:512
    v_mfma_f32_16x16x32_bf16 v[136:139], v[44:47], v[24:27], v[136:139]
    ds_read_b128 v[88:91], v23 offset:768
    v_mfma_f32_16x16x32_bf16 v[120:123], v[52:55], v[48:51], v[120:123]
    ds_read_b128 v[92:95], v23 offset:1024
    v_mfma_f32_16x16x32_bf16 v[124:127], v[56:59], v[48:51], v[124:127]
    ds_read_b128 v[96:99], v21 offset:4096
    v_mfma_f32_16x16x32_bf16 v[128:131], v[60:63], v[48:51], v[128:131]
    ds_read_b128 v[100:103], v23 offset:5120
    v_mfma_f32_16x16x32_bf16 v[132:135], v[64:67], v[48:51], v[132:135]
    ds_read_b128 v[104:107], v23 offset:5376
    v_mfma_f32_16x16x32_bf16 v[136:139], v[68:71], v[48:51], v[136:139]
    ds_read_b128 v[108:111], v23 offset:5632
    ds_read_b128 v[112:115], v23 offset:5888
    ds_read_b128 v[116:119], v23 offset:6144
    s_add_u32 s19, s19, 20480
    s_cmp_eq_u32 s19, 143360
    s_cselect_b32 s19, 0, s19
    v_add_u32 v21, s19, v18
    v_add_u32 v23, s19, v20
    s_waitcnt lgkmcnt(0)
    s_barrier
    v_mfma_f32_16x16x32_bf16 v[120:123], v[76:79], v[72:75], v[120:123]
    ds_read_b128 v[24:27], v21 offset:0
    v_mfma_f32_16x16x32_bf16 v[124:127], v[80:83], v[72:75], v[124:127]
    ds_read_b128 v[28:31], v23 offset:0
    v_mfma_f32_16x16x32_bf16 v[128:131], v[84:87], v[72:75], v[128:131]
    ds_read_b128 v[32:35], v23 offset:256
    v_mfma_f32_16x16x32_bf16 v[132:135], v[88:91], v[72:75], v[132:135]
    ds_read_b128 v[36:39], v23 offset:512
    v_mfma_f32_16x16x32_bf16 v[136:139], v[92:95], v[72:75], v[136:139]
    ds_read_b128 v[40:43], v23 offset:768
    v_mfma_f32_16x16x32_bf16 v[120:123], v[100:103], v[96:99], v[120:123]
    ds_read_b128 v[44:47], v23 offset:1024
    v_mfma_f32_16x16x32_bf16 v[124:127], v[104:107], v[96:99], v[124:127]
    ds_read_b128 v[48:51], v21 offset:4096
    v_mfma_f32_16x16x32_bf16 v[128:131], v[108:111], v[96:99], v[128:131]
    ds_read_b128 v[52:55], v23 offset:5120
    v_mfma_f32_16x16x32_bf16 v[132:135], v[112:115], v[96:99], v[132:135]
    ds_read_b128 v[56:59], v23 offset:5376
    v_mfma_f32_16x16x32_bf16 v[136:139], v[116:119], v[96:99], v[136:139]
    ds_read_b128 v[60:63], v23 offset:5632
    ds_read_b128 v[64:67], v23 offset:5888
    ds_read_b128 v[68:71], v23 offset:6144
    s_add_u32 s19, s19, 20480
    s_cmp_eq_u32 s19, 143360
    s_cselect_b32 s19, 0, s19
    v_add_u32 v21, s19, v18
    v_add_u32 v23, s19, v20
    s_waitcnt lgkmcnt(0)
    s_barrier
    s_sub_u32 s20, s20, 1
    s_cmp_lg_u32 s20, 0
    s_cbranch_scc1 L_gemm3_1_kernel_loop
    s_nop 7
    s_nop 1
    s_waitcnt vmcnt(0) lgkmcnt(0)
    s_mov_b32 s40, s32
    s_mov_b32 s41, s33
    s_mov_b32 s42, 2621440
    s_mov_b32 s43, 0x00020000
    v_cvt_pk_bf16_f32 v154, v120, v121
    v_lshlrev_b32 v120, 16, v154
    v_and_b32 v121, 0xffff0000, v154
    v_cvt_pk_bf16_f32 v154, v122, v123
    v_lshlrev_b32 v122, 16, v154
    v_and_b32 v123, 0xffff0000, v154
    v_lshlrev_b32 v150, 16, v140
    v_and_b32 v151, 0xffff0000, v140
    v_lshlrev_b32 v152, 16, v141
    v_and_b32 v153, 0xffff0000, v141
    v_add_f32 v120, v120, v150
    v_add_f32 v121, v121, v151
    v_add_f32 v122, v122, v152
    v_add_f32 v123, v123, v153
    v_cvt_pk_bf16_f32 v120, v120, v121
    v_cvt_pk_bf16_f32 v121, v122, v123
    buffer_store_dwordx2 v[120:121], v9, s[40:43], 0 offen offset:0
    v_cvt_pk_bf16_f32 v154, v124, v125
    v_lshlrev_b32 v124, 16, v154
    v_and_b32 v125, 0xffff0000, v154
    v_cvt_pk_bf16_f32 v154, v126, v127
    v_lshlrev_b32 v126, 16, v154
    v_and_b32 v127, 0xffff0000, v154
    v_lshlrev_b32 v150, 16, v142
    v_and_b32 v151, 0xffff0000, v142
    v_lshlrev_b32 v152, 16, v143
    v_and_b32 v153, 0xffff0000, v143
    v_add_f32 v124, v124, v150
    v_add_f32 v125, v125, v151
    v_add_f32 v126, v126, v152
    v_add_f32 v127, v127, v153
    v_cvt_pk_bf16_f32 v124, v124, v125
    v_cvt_pk_bf16_f32 v125, v126, v127
    buffer_store_dwordx2 v[124:125], v9, s[40:43], 0 offen offset:32
    v_cvt_pk_bf16_f32 v154, v128, v129
    v_lshlrev_b32 v128, 16, v154
    v_and_b32 v129, 0xffff0000, v154
    v_cvt_pk_bf16_f32 v154, v130, v131
    v_lshlrev_b32 v130, 16, v154
    v_and_b32 v131, 0xffff0000, v154
    v_lshlrev_b32 v150, 16, v144
    v_and_b32 v151, 0xffff0000, v144
    v_lshlrev_b32 v152, 16, v145
    v_and_b32 v153, 0xffff0000, v145
    v_add_f32 v128, v128, v150
    v_add_f32 v129, v129, v151
    v_add_f32 v130, v130, v152
    v_add_f32 v131, v131, v153
    v_cvt_pk_bf16_f32 v128, v128, v129
    v_cvt_pk_bf16_f32 v129, v130, v131
    buffer_store_dwordx2 v[128:129], v9, s[40:43], 0 offen offset:64
    v_cvt_pk_bf16_f32 v154, v132, v133
    v_lshlrev_b32 v132, 16, v154
    v_and_b32 v133, 0xffff0000, v154
    v_cvt_pk_bf16_f32 v154, v134, v135
    v_lshlrev_b32 v134, 16, v154
    v_and_b32 v135, 0xffff0000, v154
    v_lshlrev_b32 v150, 16, v146
    v_and_b32 v151, 0xffff0000, v146
    v_lshlrev_b32 v152, 16, v147
    v_and_b32 v153, 0xffff0000, v147
    v_add_f32 v132, v132, v150
    v_add_f32 v133, v133, v151
    v_add_f32 v134, v134, v152
    v_add_f32 v135, v135, v153
    v_cvt_pk_bf16_f32 v132, v132, v133
    v_cvt_pk_bf16_f32 v133, v134, v135
    buffer_store_dwordx2 v[132:133], v9, s[40:43], 0 offen offset:96
    v_cvt_pk_bf16_f32 v154, v136, v137
    v_lshlrev_b32 v136, 16, v154
    v_and_b32 v137, 0xffff0000, v154
    v_cvt_pk_bf16_f32 v154, v138, v139
    v_lshlrev_b32 v138, 16, v154
    v_and_b32 v139, 0xffff0000, v154
    v_lshlrev_b32 v150, 16, v148
    v_and_b32 v151, 0xffff0000, v148
    v_lshlrev_b32 v152, 16, v149
    v_and_b32 v153, 0xffff0000, v149
    v_add_f32 v136, v136, v150
    v_add_f32 v137, v137, v151
    v_add_f32 v138, v138, v152
    v_add_f32 v139, v139, v153
    v_cvt_pk_bf16_f32 v136, v136, v137
    v_cvt_pk_bf16_f32 v137, v138, v139
    buffer_store_dwordx2 v[136:137], v9, s[40:43], 0 offen offset:128
L_gemm3_1_kernel_end:
    s_endpgm
L_text_end:
.section .rodata,"a"
.p2align 6
.amdhsa_kernel prep_kernel
  .amdhsa_next_free_vgpr 128
  .amdhsa_next_free_sgpr 102
  .amdhsa_accum_offset 128
  .amdhsa_group_segment_fixed_size 0
  .amdhsa_kernarg_size 112
  .amdhsa_user_sgpr_count 2
  .amdhsa_user_sgpr_kernarg_segment_ptr 1
  .amdhsa_system_sgpr_workgroup_id_x 1
.end_amdhsa_kernel
.p2align 6
.amdhsa_kernel conv_kernel
  .amdhsa_next_free_vgpr 112
  .amdhsa_next_free_sgpr 102
  .amdhsa_accum_offset 112
  .amdhsa_group_segment_fixed_size 0
  .amdhsa_kernarg_size 112
  .amdhsa_user_sgpr_count 2
  .amdhsa_user_sgpr_kernarg_segment_ptr 1
  .amdhsa_system_sgpr_workgroup_id_x 1
.end_amdhsa_kernel
.p2align 6
.amdhsa_kernel lnx0_kernel
  .amdhsa_next_free_vgpr 136
  .amdhsa_next_free_sgpr 102
  .amdhsa_accum_offset 136
  .amdhsa_group_segment_fixed_size 0
  .amdhsa_kernarg_size 112
  .amdhsa_user_sgpr_count 2
  .amdhsa_user_sgpr_kernarg_segment_ptr 1
  .amdhsa_system_sgpr_workgroup_id_x 1
.end_amdhsa_kernel
.p2align 6
.amdhsa_kernel gemm1_0_kernel
  .amdhsa_next_free_vgpr 200
  .amdhsa_next_free_sgpr 102
  .amdhsa_accum_offset 200
  .amdhsa_group_segment_fixed_size 0
  .amdhsa_kernarg_size 112
  .amdhsa_user_sgpr_count 2
  .amdhsa_user_sgpr_kernarg_segment_ptr 1
  .amdhsa_system_sgpr_workgroup_id_x 1
.end_amdhsa_kernel
.p2align 6
.amdhsa_kernel lnz0_kernel
  .amdhsa_next_free_vgpr 120
  .amdhsa_next_free_sgpr 102
  .amdhsa_accum_offset 120
  .amdhsa_group_segment_fixed_size 0
  .amdhsa_kernarg_size 112
  .amdhsa_user_sgpr_count 2
  .amdhsa_user_sgpr_kernarg_segment_ptr 1
  .amdhsa_system_sgpr_workgroup_id_x 1
.end_amdhsa_kernel
.p2align 6
.amdhsa_kernel gemm2_0_kernel
  .amdhsa_next_free_vgpr 160
  .amdhsa_next_free_sgpr 102
  .amdhsa_accum_offset 160
  .amdhsa_group_segment_fixed_size 0
  .amdhsa_kernarg_size 112
  .amdhsa_user_sgpr_count 2
  .amdhsa_user_sgpr_kernarg_segment_ptr 1
  .amdhsa_system_sgpr_workgroup_id_x 1
.end_amdhsa_kernel
.p2align 6
.amdhsa_kernel gemm3_0_kernel
  .amdhsa_next_free_vgpr 164
  .amdhsa_next_free_sgpr 102
  .amdhsa_accum_offset 164
  .amdhsa_group_segment_fixed_size 0
  .amdhsa_kernarg_size 112
  .amdhsa_user_sgpr_count 2
  .amdhsa_user_sgpr_kernarg_segment_ptr 1
  .amdhsa_system_sgpr_workgroup_id_x 1
.end_amdhsa_kernel
.p2align 6
.amdhsa_kernel lnx1_kernel
  .amdhsa_next_free_vgpr 136
  .amdhsa_next_free_sgpr 102
  .amdhsa_accum_offset 136
  .amdhsa_group_segment_fixed_size 0
  .amdhsa_kernarg_size 112
  .amdhsa_user_sgpr_count 2
  .amdhsa_user_sgpr_kernarg_segment_ptr 1
  .amdhsa_system_sgpr_workgroup_id_x 1
.end_amdhsa_kernel
.p2align 6
.amdhsa_kernel gemm3_1_kernel
  .amdhsa_next_free_vgpr 164
  .amdhsa_next_free_sgpr 102
  .amdhsa_accum_offset 164
  .amdhsa_group_segment_fixed_size 0
  .amdhsa_kernarg_size 112
  .amdhsa_user_sgpr_count 2
  .amdhsa_user_sgpr_kernarg_segment_ptr 1
  .amdhsa_system_sgpr_workgroup_id_x 1
.end_amdhsa_kernel
```
